```python
import torch

def _softmax(x, axis=-1):
    return torch.softmax(x, dim=axis)
def _gelu(x):
    return torch.nn.functional.gelu(x, approximate="tanh")
def _silu(x):
    return torch.nn.functional.silu(x)
def _sigmoid(x):
    return torch.sigmoid(x)
def _layernorm(x, axis=-1, eps=1e-5):
    m = x.mean(dim=axis, keepdim=True)
    v = x.var(dim=axis, keepdim=True, unbiased=False)
    return (x - m) / torch.sqrt(v + eps)
def _scatter_add(tgt, idx, src, axis=0):
    return tgt.clone().index_add_(axis, idx, src)
def _segment_sum(src, seg, n):
    out = torch.zeros((n,) + src.shape[1:], dtype=src.dtype)
    return out.index_add_(0, seg, src)
def _pad(x, pw):
    flat = tuple(v for pair in reversed(pw) for v in pair)
    return torch.nn.functional.pad(x, flat)

kernel_name = 'gated_mix__grouped_kv_mqa__glu_gated_glu__prompt'

def setup_inputs():

    _w = (lambda a: (lambda t: t.to(torch.bfloat16) if t.is_floating_point() else t)(torch.as_tensor(a)))
    def _A_setup():
        B, S, D, H = 1, 2048, 512, 32
        Dh = D // H
        return {
            "x": _w((lambda *s: torch.randn(*s, dtype=torch.bfloat16) * 0.05)(B, S, D)),
            "wq": _w((lambda *s: torch.randn(*s, dtype=torch.bfloat16) * 0.8)(D, H * Dh)),
            "wk": _w((lambda *s: torch.randn(*s, dtype=torch.bfloat16) * 0.8)(D, Dh)),
            "wv": _w((lambda *s: torch.randn(*s, dtype=torch.bfloat16) * 0.2)(D, Dh)),
            "wo": _w((lambda *s: torch.randn(*s, dtype=torch.bfloat16) * 0.2)(H * Dh, D)),
        }
    _A_in = _A_setup()

    def _B_setup():
        B, S, D, F = 1, 2048, 512, 1792
        return {
            "x": _w((lambda *s: torch.randn(*s, dtype=torch.bfloat16) * 0.05)(B, S, D)),
            "w_gate": _w((lambda *s: torch.randn(*s, dtype=torch.bfloat16) * 0.4)(D, F)),
            "w_up": _w((lambda *s: torch.randn(*s, dtype=torch.bfloat16) * 0.05)(D, F)),
            "w_down": _w((lambda *s: torch.randn(*s, dtype=torch.bfloat16) * 0.05)(F, D)),
        }
    _B_in = _B_setup()

    return {
        "A_x": _A_in["x"],
        "A_wq": _A_in["wq"],
        "A_wk": _A_in["wk"],
        "A_wv": _A_in["wv"],
        "A_wo": _A_in["wo"],
        "B_x": _B_in["x"],
        "B_w_gate": _B_in["w_gate"],
        "B_w_up": _B_in["w_up"],
        "B_w_down": _B_in["w_down"],
        "gate_w": _w((lambda *s: torch.randn(*s, dtype=torch.bfloat16) * 0.05)(512) * 16.0),
    }

def reference(A_x, A_wq, A_wk, A_wv, A_wo, B_x, B_w_gate, B_w_up, B_w_down, gate_w):
    def _A_ref(x, wq, wk, wv, wo):
        B, S, D = x.shape
        H = 32
        Dh = D // H
        q = (lambda x, *d: x.permute(*d))((x @ wq).reshape(B, S, H, Dh), 0, 2, 1, 3)
        k = x @ wk
        v = x @ wv
        scores = torch.einsum("bhqd,bkd->bhqk", q, k) * (Dh ** -0.5)
        p = _softmax(scores, axis=-1)
        o = torch.einsum("bhqk,bkd->bhqd", p, v)
        return (lambda x, *d: x.permute(*d))(o, 0, 2, 1, 3).reshape(B, S, H * Dh) @ wo

    def _B_ref(x, w_gate, w_up, w_down):
        g = torch.einsum("bsd,df->bsf", x, w_gate)
        u = torch.einsum("bsd,df->bsf", x, w_up)
        h = _sigmoid(g) * u
        return torch.einsum("bsf,fd->bsd", h, w_down)

    x = A_x
    g = _sigmoid((x * gate_w).sum(-1, keepdims=True))
    a = _A_ref(x, A_wq, A_wk, A_wv, A_wo)
    b = _B_ref(x, B_w_gate, B_w_up, B_w_down)
    return g * a + (1 - g) * b
```

```asm
; @launch grid=(256,1,1) block=(512,1,1) lds=163840
.amdgcn_target "amdgcn-amd-amdhsa--gfx950"
.text
.globl gated_mix__grouped_kv_mqa__glu_gated_glu__prompt_kernel
.p2align 8
.type gated_mix__grouped_kv_mqa__glu_gated_glu__prompt_kernel,@function
gated_mix__grouped_kv_mqa__glu_gated_glu__prompt_kernel:
L_start:
    s_cmp_ge_u32 s2, 256
    s_cbranch_scc1 L_end
    s_load_dwordx16 s[36:51], s[0:1], 0
    s_load_dwordx8 s[52:59], s[0:1], 64
    s_load_dwordx2 s[60:61], s[0:1], 96
    v_lshrrev_b32 v1, 6, v0
    v_and_b32 v0, 63, v0
    s_and_b32 s3, s2, 7
    v_readfirstlane_b32 s32, v1
    s_lshr_b32 s31, s2, 3
    s_and_b32 s28, s3, 1
    s_lshl_b32 s28, s28, 3
    s_and_b32 s62, s31, 7
    s_add_u32 s28, s28, s62
    s_lshr_b32 s29, s3, 1
    s_lshl_b32 s29, s29, 2
    s_lshr_b32 s63, s31, 3
    s_add_u32 s29, s29, s63
    s_lshr_b32 s64, s3, 2
    s_bfe_u32 s65, s3, 0x10001
    s_mul_i32 s100, s64, 7
    s_add_u32 s66, s100, 6
    s_add_u32 s64, s64, 14
    s_lshr_b32 s67, s62, 2
    s_cmp_eq_u32 s67, s65
    s_cselect_b32 s66, s66, s64
    s_mul_i32 s65, s65, 3
    s_add_u32 s100, s100, s65
    s_add_u32 s100, s100, s63
    s_cmp_eq_u32 s63, 3
    s_cselect_b32 s100, s66, s100
    s_lshl_b32 s63, s63, 0
    s_add_u32 s30, s62, s63
    s_and_b32 s30, s30, 3
    s_mov_b32 s64, 1985160208
    s_cmp_eq_u32 s30, 1
    s_cselect_b32 s64, 1984123393, s64
    s_cmp_eq_u32 s30, 2
    s_cselect_b32 s64, 1967534338, s64
    s_cmp_eq_u32 s30, 3
    s_cselect_b32 s64, 1702109443, s64
    s_mov_b32 s30, s64
    s_lshr_b32 s33, s32, 2
    s_and_b32 s34, s32, 3
    v_lshlrev_b32 v2, 4, v0
    v_lshrrev_b32 v4, 4, v0
    v_lshrrev_b32 v7, 5, v0
    v_and_b32 v14, 1, v4
    v_lshlrev_b32 v18, 2, v0
    v_lshlrev_b32 v29, 7, v0
    s_lshl_b32 s69, s34, 10
    s_cmp_eq_u32 s33, 1
    s_cbranch_scc0 L_comp
    s_setprio 3
    v_and_b32 v5, 7, v0
    v_xor_b32 v5, v5, v4
    v_lshlrev_b32 v5, 4, v5
    v_lshrrev_b32 v8, 3, v0
    v_lshl_add_u32 v3, v8, 10, v5
    v_xor_b32 v15, 64, v3
    v_add_u32 v15, 0x2000, v15
    s_lshl_b32 s68, s28, 17
    s_lshl_b32 s64, s34, 15
    s_add_u32 s68, s68, s64
    s_lshl_b32 s76, s34, 12
    s_lshl_b32 s63, s100, 8
    v_bfe_u32 v5, v0, 1, 3
    v_lshlrev_b32 v6, 1, v4
    v_xor_b32 v5, v5, v6
    s_lshr_b32 s62, s34, 1
    v_xor_b32 v5, s62, v5
    v_lshlrev_b32 v5, 5, v5
    v_and_b32 v6, 1, v0
    v_lshl_add_u32 v5, v6, 4, v5
    s_lshl_b32 s62, s34, 2
    v_add_u32 v6, s62, v4
    v_mul_u32_u24 v6, 3584, v6
    v_add3_u32 v10, v5, v6, s63
    v_lshrrev_b32 v5, 2, v0
    v_and_b32 v6, 3, v0
    v_lshlrev_b32 v6, 4, v6
    v_lshl_add_u32 v12, v5, 10, v6
    s_lshl_b32 s62, s34, 14
    s_lshl_b32 s63, s29, 6
    s_add_u32 s62, s62, s63
    v_add_u32 v12, s62, v12
    s_add_u32 s75, s76, 147456
    v_mov_b32 v8, 0
    s_mov_b32 s6, 2097152
    s_mov_b32 s7, 0x00020000
    s_mov_b32 s22, 524288
    s_mov_b32 s23, 0x00020000
    s_mov_b32 s14, 1835008
    s_mov_b32 s15, 0x00020000
    s_mov_b32 s18, 1835008
    s_mov_b32 s19, 0x00020000
    s_mov_b32 s26, 256
    s_mov_b32 s27, 0x00020000
    s_waitcnt lgkmcnt(0)
    s_mov_b32 s46, 0
    s_mov_b32 s47, 0
    s_mov_b32 s4, s36
    s_and_b32 s5, s37, 0xffff
    s_mov_b32 s20, s38
    s_and_b32 s21, s39, 0xffff
    s_mov_b32 s12, s48
    s_and_b32 s13, s49, 0xffff
    s_mov_b32 s16, s50
    s_and_b32 s17, s51, 0xffff
    s_mov_b32 s24, s58
    s_and_b32 s25, s59, 0xffff
    s_cmp_ge_u32 s100, 14
    s_cbranch_scc1 L_lkv
    s_and_b32 s62, s30, 7
    s_lshr_b32 s30, s30, 4
    s_lshl_b32 s63, s62, 7
    s_add_u32 m0, s76, s47
    s_add_u32 s63, s63, s68
    buffer_load_dwordx4 v3, s[4:7], s63 offen lds
    s_add_u32 m0, m0, 1024
    s_nop 0
    buffer_load_dwordx4 v15, s[4:7], s63 offen lds
    s_add_u32 m0, m0, 1024
    s_add_u32 s63, s63, 16384
    buffer_load_dwordx4 v3, s[4:7], s63 offen lds
    s_add_u32 m0, m0, 1024
    s_nop 0
    buffer_load_dwordx4 v15, s[4:7], s63 offen lds
    s_and_b32 s63, s46, 3
    s_lshl_b32 s63, s63, 10
    s_add_u32 m0, s75, s63
    s_lshl_b32 s63, s62, 16
    buffer_load_dwordx4 v12, s[20:23], s63 offen lds
    s_add_u32 m0, s69, s47
    s_add_u32 m0, m0, 16384
    s_mul_i32 s63, s62, 229376
    buffer_load_dwordx4 v10, s[12:15], s63 offen lds
    s_add_u32 m0, m0, 16384
    s_nop 0
    buffer_load_dwordx4 v10, s[16:19], s63 offen lds
    s_sub_u32 m0, m0, 12288
    s_add_u32 s63, s63, 57344
    buffer_load_dwordx4 v10, s[12:15], s63 offen lds
    s_add_u32 m0, m0, 16384
    s_nop 0
    buffer_load_dwordx4 v10, s[16:19], s63 offen lds
    s_mov_b32 s70, s63
    s_mov_b32 s74, s62
    s_cmp_eq_u32 s33, 0
    s_cselect_b32 s62, 98304, 0
    v_add_u32 v20, s62, v2
    v_and_b32 v16, 15, v0
    v_lshlrev_b32 v16, 4, v16
    v_lshl_add_u32 v16, v7, 8, v16
    s_add_u32 s62, s62, 1024
    v_add_u32 v21, s62, v16
    v_mov_b32 v19, 0xdddd
    s_mov_b32 s72, 0xffff
    s_mov_b32 s73, 0xffff
    s_and_b32 s62, s2, 3
    s_bfe_u32 s35, s2, 0x30003
    s_lshl_b32 s35, s35, 2
    s_add_u32 s35, s35, s62
    s_lshr_b32 s71, s2, 6
    s_and_b32 s62, s2, 4
    s_add_u32 s71, s71, s62
    v_lshrrev_b32 v5, 3, v0
    v_bfe_u32 v6, v0, 2, 1
    v_xor_b32 v6, v6, v14
    v_lshlrev_b32 v6, 6, v6
    v_lshl_add_u32 v24, v5, 10, v6
    v_and_b32 v17, 3, v0
    v_lshl_add_u32 v24, v17, 4, v24
    s_lshl_b32 s62, s71, 7
    v_add_u32 v24, s62, v24
    v_bfe_u32 v5, v0, 2, 2
    v_lshl_add_u32 v6, v7, 2, v5
    v_lshlrev_b32 v6, 7, v6
    v_bfe_u32 v5, v0, 3, 1
    v_lshl_add_u32 v6, v5, 6, v6
    v_lshl_add_u32 v6, v14, 5, v6
    v_lshl_add_u32 v25, v17, 3, v6
    s_lshl_b32 s101, s32, 12
    s_add_u32 s101, s101, 65536
    v_add_u32 v22, s101, v25
    v_xor_b32 v23, 64, v22
    s_lshl_b32 s62, s34, 12
    s_add_u32 s62, s62, 147456
    v_add_u32 v16, s62, v2
    s_lshr_b32 s62, s35, 1
    s_sub_u32 s62, s62, s28
    v_mul_i32_i24 v17, s62, v7
    v_add_u32 v17, s28, v17
    v_lshlrev_b32 v17, 11, v17
    v_and_b32 v5, 0x780, v29
    v_or_b32 v17, v17, v5
    v_and_b32 v5, 27, v0
    v_cmp_eq_u32 vcc, 16, v5
    v_mov_b32 v5, 0x3f803f80
    s_nop 0
    v_cndmask_b32 v26, 0, v5, vcc
    s_mov_b32 s62, s74
    v_mov_b32 v56, 0
    v_mov_b32 v57, 0
    v_mov_b32 v58, 0
    v_mov_b32 v59, 0
    v_mov_b32 v60, 0
    v_mov_b32 v61, 0
    v_mov_b32 v62, 0
    v_mov_b32 v63, 0
    v_mfma_f32_32x32x16_bf16 v[64:79], v[56:59], v[56:59], 0
    v_mfma_f32_32x32x16_bf16 v[80:95], v[56:59], v[56:59], 0
    v_mov_b32 v104, v26
    v_mov_b32 v105, v26
    v_mov_b32 v106, v26
    v_mov_b32 v107, v26
    v_mov_b32 v108, v26
    v_mov_b32 v109, v26
    v_mov_b32 v110, v26
    v_mov_b32 v111, v26
    v_mov_b32 v112, v26
    v_mov_b32 v113, v26
    v_mov_b32 v114, v26
    v_mov_b32 v115, v26
    v_mov_b32 v116, v26
    v_mov_b32 v117, v26
    v_mov_b32 v118, v26
    v_mov_b32 v119, v26
    v_add_u32 v120, 15360, v24
    v_add_u32 v121, 7168, v24
    s_mov_b32 s63, s70
    s_sub_u32 m0, m0, 12288
    s_add_u32 s63, s63, 57344
    buffer_load_dwordx4 v10, s[12:15], s63 offen lds
    s_add_u32 m0, m0, 16384
    s_nop 0
    buffer_load_dwordx4 v10, s[16:19], s63 offen lds
    s_sub_u32 m0, m0, 12288
    s_add_u32 s63, s63, 57344
    buffer_load_dwordx4 v10, s[12:15], s63 offen lds
    s_add_u32 m0, m0, 16384
    s_nop 0
    buffer_load_dwordx4 v10, s[16:19], s63 offen lds
    s_add_u32 s46, s46, 1
    s_add_u32 s47, s47, 49152
    s_cmp_eq_u32 s47, 147456
    s_cselect_b32 s47, 0, s47
    s_and_b32 s62, s30, 7
    s_lshr_b32 s30, s30, 4
    s_lshl_b32 s63, s62, 7
    s_add_u32 m0, s76, s47
    s_add_u32 s63, s63, s68
    buffer_load_dwordx4 v3, s[4:7], s63 offen lds
    s_add_u32 m0, m0, 1024
    s_nop 0
    buffer_load_dwordx4 v15, s[4:7], s63 offen lds
    s_add_u32 m0, m0, 1024
    s_add_u32 s63, s63, 16384
    buffer_load_dwordx4 v3, s[4:7], s63 offen lds
    s_add_u32 m0, m0, 1024
    s_nop 0
    buffer_load_dwordx4 v15, s[4:7], s63 offen lds
    s_and_b32 s63, s46, 3
    s_lshl_b32 s63, s63, 10
    s_add_u32 m0, s75, s63
    s_lshl_b32 s63, s62, 16
    buffer_load_dwordx4 v12, s[20:23], s63 offen lds
    s_waitcnt vmcnt(5)
    s_barrier
    s_add_u32 m0, s69, s47
    s_add_u32 m0, m0, 16384
    s_mul_i32 s63, s62, 229376
    buffer_load_dwordx4 v10, s[12:15], s63 offen lds
    s_add_u32 m0, m0, 16384
    s_nop 0
    buffer_load_dwordx4 v10, s[16:19], s63 offen lds
    s_sub_u32 m0, m0, 12288
    s_add_u32 s63, s63, 57344
    buffer_load_dwordx4 v10, s[12:15], s63 offen lds
    s_add_u32 m0, m0, 16384
    s_nop 0
    buffer_load_dwordx4 v10, s[16:19], s63 offen lds
    s_sub_u32 m0, m0, 12288
    s_add_u32 s63, s63, 57344
    buffer_load_dwordx4 v10, s[12:15], s63 offen lds
    s_add_u32 m0, m0, 16384
    s_nop 0
    buffer_load_dwordx4 v10, s[16:19], s63 offen lds
    s_sub_u32 m0, m0, 12288
    s_add_u32 s63, s63, 57344
    buffer_load_dwordx4 v10, s[12:15], s63 offen lds
    s_add_u32 m0, m0, 16384
    s_nop 0
    buffer_load_dwordx4 v10, s[16:19], s63 offen lds
    s_add_u32 s46, s46, 1
    s_add_u32 s47, s47, 49152
    s_cmp_eq_u32 s47, 147456
    s_cselect_b32 s47, 0, s47
    s_mov_b32 s70, 5
    s_mov_b32 s8, s60
    s_and_b32 s9, s61, 0xffff
    s_mov_b32 s10, 9617408
    s_mov_b32 s11, 0x00020000
    s_mov_b32 s74, 9576448
L_ld:
    buffer_load_dword v30, v8, s[24:27], 0 offen sc1
L_ldi:
    s_and_b32 s62, s30, 7
    s_lshr_b32 s30, s30, 4
    s_lshl_b32 s63, s62, 7
    s_add_u32 m0, s76, s47
    s_add_u32 s63, s63, s68
    buffer_load_dwordx4 v3, s[4:7], s63 offen lds
    s_add_u32 m0, m0, 1024
    s_nop 0
    buffer_load_dwordx4 v15, s[4:7], s63 offen lds
    s_add_u32 m0, m0, 1024
    s_add_u32 s63, s63, 16384
    buffer_load_dwordx4 v3, s[4:7], s63 offen lds
    s_add_u32 m0, m0, 1024
    s_nop 0
    buffer_load_dwordx4 v15, s[4:7], s63 offen lds
    s_and_b32 s63, s46, 3
    s_lshl_b32 s63, s63, 10
    s_add_u32 m0, s75, s63
    s_lshl_b32 s63, s62, 16
    buffer_load_dwordx4 v12, s[20:23], s63 offen lds
    s_add_u32 m0, s69, s47
    s_add_u32 m0, m0, 16384
    s_mul_i32 s63, s62, 229376
    buffer_load_dwordx4 v10, s[12:15], s63 offen lds
    s_add_u32 m0, m0, 16384
    s_nop 0
    buffer_load_dwordx4 v10, s[16:19], s63 offen lds
    s_sub_u32 m0, m0, 12288
    s_add_u32 s63, s63, 57344
    buffer_load_dwordx4 v10, s[12:15], s63 offen lds
    s_add_u32 m0, m0, 16384
    s_nop 0
    buffer_load_dwordx4 v10, s[16:19], s63 offen lds
    s_sub_u32 m0, m0, 12288
    s_add_u32 s63, s63, 57344
    buffer_load_dwordx4 v10, s[12:15], s63 offen lds
    s_add_u32 m0, m0, 16384
    s_nop 0
    buffer_load_dwordx4 v10, s[16:19], s63 offen lds
    s_sub_u32 m0, m0, 12288
    s_add_u32 s63, s63, 57344
    buffer_load_dwordx4 v10, s[12:15], s63 offen lds
    s_add_u32 m0, m0, 16384
    s_nop 0
    buffer_load_dwordx4 v10, s[16:19], s63 offen lds
    s_add_u32 s46, s46, 1
    s_add_u32 s47, s47, 49152
    s_cmp_eq_u32 s47, 147456
    s_cselect_b32 s47, 0, s47
    s_sub_u32 s70, s70, 1
    s_waitcnt vmcnt(13)
    s_barrier
    s_cbranch_scc0 L_ld
    s_mov_b32 s70, 1048576
L_kvc3:
    v_cmp_ne_u32 vcc, 0, v30
    s_cmp_eq_u64 vcc, -1
    s_cbranch_scc1 L_kvc3_ok
    s_sub_u32 s70, s70, 1
    s_cbranch_scc1 L_kvc3_ok
    s_sleep 12
    buffer_load_dword v30, v8, s[24:27], 0 offen sc1
    s_waitcnt vmcnt(0)
    s_branch L_kvc3
L_kvc3_ok:
    buffer_load_dwordx2 v[30:31], v29, s[8:11], s74 offen sc1
    s_waitcnt vmcnt(0)
L_ld6:
    s_mov_b32 s70, 1048576
L_kvp:
    v_min_u32 v30, v30, v31
    v_cmp_ne_u32 vcc, 0, v30
    s_cmp_eq_u64 vcc, -1
    s_cbranch_scc1 L_kvp_ok
    s_sub_u32 s70, s70, 1
    s_cbranch_scc1 L_kvp_ok
    s_sleep 8
    buffer_load_dwordx2 v[30:31], v29, s[8:11], s74 offen sc1
    s_waitcnt vmcnt(0)
    s_branch L_kvp
L_kvp_ok:
    s_lshl_b32 s46, s31, 2
    s_lshl_b32 s62, s34, 2
    s_add_u32 s46, s46, s62
    s_lshl_b32 s64, s34, 12
    s_add_u32 s62, s46, 0
    s_and_b32 s62, s62, 127
    s_lshl_b32 s62, s62, 10
    s_add_u32 m0, s64, 98304
    s_add_u32 s62, s62, 9437184
    buffer_load_dwordx4 v2, s[8:11], s62 offen offset:0 sc1 lds
    buffer_load_dwordx4 v2, s[8:11], s62 offen offset:1024 sc1 lds
    buffer_load_dwordx4 v2, s[8:11], s62 offen offset:2048 sc1 lds
    buffer_load_dwordx4 v2, s[8:11], s62 offen offset:3072 sc1 lds
    s_add_u32 s62, s46, 16
    s_and_b32 s62, s62, 127
    s_lshl_b32 s62, s62, 10
    s_add_u32 m0, s64, 114688
    s_add_u32 s62, s62, 9437184
    buffer_load_dwordx4 v2, s[8:11], s62 offen offset:0 sc1 lds
    buffer_load_dwordx4 v2, s[8:11], s62 offen offset:1024 sc1 lds
    buffer_load_dwordx4 v2, s[8:11], s62 offen offset:2048 sc1 lds
    buffer_load_dwordx4 v2, s[8:11], s62 offen offset:3072 sc1 lds
    s_waitcnt vmcnt(8)
    s_barrier
    s_mov_b32 s12, s52
    s_and_b32 s13, s53, 0xffff
    s_mov_b32 s14, 1835008
    s_mov_b32 s15, 0x00020000
    s_mov_b32 s16, s44
    s_and_b32 s17, s45, 0xffff
    s_mov_b32 s18, 524288
    s_mov_b32 s19, 0x00020000
    s_mov_b32 s20, s56
    s_and_b32 s21, s57, 0xffff
    s_mov_b32 s22, 2097152
    s_mov_b32 s23, 0x00020000
    s_mov_b32 s68, s101
    s_lshl_b32 s99, s35, 1
    s_add_u32 s99, s99, s33
    s_mul_i32 s62, s32, 14
    s_mul_i32 s74, s99, 144
    s_add_u32 s74, s74, s62
    s_lshl_b32 s74, s74, 10
    s_xor_b32 s63, s99, 1
    s_mul_i32 s63, s63, 144
    s_add_u32 s63, s63, s62
    s_lshl_b32 s63, s63, 10
    s_add_u32 s4, s8, s74
    s_addc_u32 s5, s9, 0
    s_mov_b32 s6, 14336
    s_add_u32 s24, s8, s63
    s_addc_u32 s25, s9, 0
    s_mov_b32 s26, 14336
    s_mov_b32 s74, 0
    s_mul_i32 s75, s32, 229376
    s_sub_u32 s75, s75, 24576
    s_barrier
    ds_read_b128 v[8:11], v16
    ds_read_b128 v[12:15], v16 offset:1024
    s_add_u32 s62, s46, 32
    s_and_b32 s62, s62, 127
    s_lshl_b32 s62, s62, 10
    s_add_u32 m0, s64, 131072
    s_add_u32 s62, s62, 9437184
    buffer_load_dwordx4 v2, s[8:11], s62 offen offset:0 sc1 lds
    buffer_load_dwordx4 v2, s[8:11], s62 offen offset:1024 sc1 lds
    buffer_load_dwordx4 v2, s[8:11], s62 offen offset:2048 sc1 lds
    buffer_load_dwordx4 v2, s[8:11], s62 offen offset:3072 sc1 lds
    s_add_u32 s62, s46, 64
    s_and_b32 s62, s62, 127
    s_lshl_b32 s62, s62, 10
    s_add_u32 m0, s64, 0
    s_add_u32 s62, s62, 9437184
    buffer_load_dwordx4 v2, s[8:11], s62 offen offset:0 sc1 lds
    buffer_load_dwordx4 v2, s[8:11], s62 offen offset:1024 sc1 lds
    buffer_load_dwordx4 v2, s[8:11], s62 offen offset:2048 sc1 lds
    buffer_load_dwordx4 v2, s[8:11], s62 offen offset:3072 sc1 lds
    s_add_u32 s62, s46, 80
    s_and_b32 s62, s62, 127
    s_lshl_b32 s62, s62, 10
    s_add_u32 m0, s64, 16384
    s_add_u32 s62, s62, 9437184
    buffer_load_dwordx4 v2, s[8:11], s62 offen offset:0 sc1 lds
    buffer_load_dwordx4 v2, s[8:11], s62 offen offset:1024 sc1 lds
    buffer_load_dwordx4 v2, s[8:11], s62 offen offset:2048 sc1 lds
    buffer_load_dwordx4 v2, s[8:11], s62 offen offset:3072 sc1 lds
    s_add_u32 s62, s46, 96
    s_and_b32 s62, s62, 127
    s_lshl_b32 s62, s62, 10
    s_add_u32 m0, s64, 32768
    s_add_u32 s62, s62, 9437184
    buffer_load_dwordx4 v2, s[8:11], s62 offen offset:0 sc1 lds
    buffer_load_dwordx4 v2, s[8:11], s62 offen offset:1024 sc1 lds
    buffer_load_dwordx4 v2, s[8:11], s62 offen offset:2048 sc1 lds
    buffer_load_dwordx4 v2, s[8:11], s62 offen offset:3072 sc1 lds
    s_add_u32 s62, s46, 112
    s_and_b32 s62, s62, 127
    s_lshl_b32 s62, s62, 10
    s_add_u32 m0, s64, 49152
    s_add_u32 s62, s62, 9437184
    buffer_load_dwordx4 v2, s[8:11], s62 offen offset:0 sc1 lds
    buffer_load_dwordx4 v2, s[8:11], s62 offen offset:1024 sc1 lds
    buffer_load_dwordx4 v2, s[8:11], s62 offen offset:2048 sc1 lds
    buffer_load_dwordx4 v2, s[8:11], s62 offen offset:3072 sc1 lds
    s_waitcnt lgkmcnt(0)
    s_add_u32 s62, s46, 48
    s_and_b32 s62, s62, 127
    s_lshl_b32 s62, s62, 10
    s_add_u32 m0, s64, 147456
    s_add_u32 s62, s62, 9437184
    buffer_load_dwordx4 v2, s[8:11], s62 offen offset:0 sc1 lds
    buffer_load_dwordx4 v2, s[8:11], s62 offen offset:1024 sc1 lds
    buffer_load_dwordx4 v2, s[8:11], s62 offen offset:2048 sc1 lds
    buffer_load_dwordx4 v2, s[8:11], s62 offen offset:3072 sc1 lds
    s_waitcnt vmcnt(8)
    s_barrier
    s_setprio 1
    s_branch L_p2
L_ldk:
    s_mov_b32 s70, 1048576
L_kvc:
    v_cmp_ne_u32 vcc, 0, v30
    s_cmp_eq_u64 vcc, -1
    s_cbranch_scc1 L_kvc_ok
    s_sub_u32 s70, s70, 1
    s_cbranch_scc1 L_kvc_ok
    s_sleep 12
    buffer_load_dword v30, v8, s[24:27], 0 offen sc1
    s_waitcnt vmcnt(0)
    s_branch L_kvc
L_kvc_ok:
    s_mov_b32 s70, 0
    buffer_load_dwordx2 v[30:31], v29, s[8:11], s74 offen sc1
    s_branch L_ldi
L_comp:
    s_waitcnt lgkmcnt(0)
    s_mov_b32 s8, s60
    s_and_b32 s9, s61, 0xffff
    s_mov_b32 s10, 9617408
    s_mov_b32 s11, 0x00020000
    s_mov_b32 s24, s58
    s_and_b32 s25, s59, 0xffff
    s_mov_b32 s26, 256
    s_mov_b32 s27, 0x00020000
    s_mov_b32 s4, s36
    s_and_b32 s5, s37, 0xffff
    s_mov_b32 s6, 2097152
    s_mov_b32 s7, 0x00020000
    s_xor_b32 s62, s34, 3
    s_xor_b32 s63, s100, 14
    s_or_b32 s62, s62, s63
    s_or_b32 s62, s62, s28
    s_cbranch_scc1 L_nclr
    v_mov_b32 v92, 0
    v_mov_b32 v93, 0
    s_mov_b32 s62, 9576448
    buffer_store_dwordx2 v[92:93], v29, s[8:11], s62 offen sc1
    s_waitcnt vmcnt(0)
    v_mov_b32 v93, 1
    s_mov_b64 exec, 1
    buffer_store_dword v93, v92, s[24:27], 0 offen sc1
    s_mov_b64 exec, -1
L_nclr:
    s_cmp_eq_u32 s33, 0
    s_cselect_b32 s62, 98304, 0
    v_add_u32 v20, s62, v2
    v_and_b32 v16, 15, v0
    v_lshlrev_b32 v16, 4, v16
    v_lshl_add_u32 v16, v7, 8, v16
    s_add_u32 s62, s62, 1024
    v_add_u32 v21, s62, v16
    v_mov_b32 v19, 0xdddd
    s_mov_b32 s72, 0xffff
    s_mov_b32 s73, 0xffff
    s_and_b32 s62, s2, 3
    s_bfe_u32 s35, s2, 0x30003
    s_lshl_b32 s35, s35, 2
    s_add_u32 s35, s35, s62
    s_lshr_b32 s71, s2, 6
    s_and_b32 s62, s2, 4
    s_add_u32 s71, s71, s62
    v_lshrrev_b32 v5, 3, v0
    v_bfe_u32 v6, v0, 2, 1
    v_xor_b32 v6, v6, v14
    v_lshlrev_b32 v6, 6, v6
    v_lshl_add_u32 v24, v5, 10, v6
    v_and_b32 v17, 3, v0
    v_lshl_add_u32 v24, v17, 4, v24
    s_lshl_b32 s62, s71, 7
    v_add_u32 v24, s62, v24
    v_bfe_u32 v5, v0, 2, 2
    v_lshl_add_u32 v6, v7, 2, v5
    v_lshlrev_b32 v6, 7, v6
    v_bfe_u32 v5, v0, 3, 1
    v_lshl_add_u32 v6, v5, 6, v6
    v_lshl_add_u32 v6, v14, 5, v6
    v_lshl_add_u32 v25, v17, 3, v6
    s_lshl_b32 s101, s32, 12
    s_add_u32 s101, s101, 65536
    v_add_u32 v22, s101, v25
    v_xor_b32 v23, 64, v22
    s_lshl_b32 s62, s34, 12
    s_add_u32 s62, s62, 147456
    v_add_u32 v16, s62, v2
    s_lshr_b32 s62, s35, 1
    s_sub_u32 s62, s62, s28
    v_mul_i32_i24 v17, s62, v7
    v_add_u32 v17, s28, v17
    v_lshlrev_b32 v17, 11, v17
    v_and_b32 v5, 0x780, v29
    v_or_b32 v17, v17, v5
    v_and_b32 v5, 27, v0
    v_cmp_eq_u32 vcc, 16, v5
    v_mov_b32 v5, 0x3f803f80
    s_nop 0
    v_cndmask_b32 v26, 0, v5, vcc
    v_and_b32 v5, 15, v0
    v_bfe_u32 v6, v0, 1, 3
    v_xor_b32 v6, v6, v4
    v_lshlrev_b32 v6, 4, v6
    v_lshl_add_u32 v245, v5, 7, v6
    s_lshl_b32 s62, s34, 12
    v_add_u32 v245, s62, v245
    v_xor_b32 v246, 64, v245
    v_xor_b32 v240, 0x1000, v245
    v_xor_b32 v241, 0x1000, v246
    v_lshlrev_b32 v5, 4, v5
    v_lshl_add_u32 v5, v14, 9, v5
    v_lshl_add_u32 v3, v7, 10, v5
    v_lshl_add_u32 v242, v7, 3, v5
    s_add_u32 s62, s62, 147456
    v_add_u32 v242, s62, v242
    v_bfe_u32 v6, v0, 2, 2
    v_lshl_add_u32 v5, v4, 3, v6
    v_lshl_add_u32 v8, v6, 1, v14
    s_and_b32 s62, s34, 1
    s_lshl_b32 s62, s62, 2
    v_xor_b32 v8, s62, v8
    v_lshlrev_b32 v8, 5, v8
    v_lshl_add_u32 v8, v5, 8, v8
    v_and_b32 v9, 3, v0
    v_lshl_add_u32 v8, v9, 3, v8
    v_add_u32 v249, 16384, v8
    v_xor_b32 v250, 32, v249
    v_xor_b32 v251, 64, v249
    v_xor_b32 v252, 0x60, v249
    v_lshl_add_u32 v8, v14, 3, v6
    v_lshlrev_b32 v8, 6, v8
    v_lshl_add_u32 v8, v7, 12, v8
    v_lshl_add_u32 v8, v9, 3, v8
    v_add_u32 v244, 147456, v8
    v_mov_b32 v84, 0
    v_mov_b32 v85, 0
    v_mov_b32 v86, 0
    v_mov_b32 v87, 0
    s_nop 1
    v_mfma_f32_32x32x16_bf16 v[96:111], v[84:87], v[84:87], 0
    v_mfma_f32_32x32x16_bf16 v[112:127], v[84:87], v[84:87], 0
    v_mfma_f32_32x32x16_bf16 v[128:143], v[84:87], v[84:87], 0
    v_mfma_f32_32x32x16_bf16 v[144:159], v[84:87], v[84:87], 0
    v_mfma_f32_32x32x16_bf16 v[160:175], v[84:87], v[84:87], 0
    v_mfma_f32_32x32x16_bf16 v[176:191], v[84:87], v[84:87], 0
    v_mfma_f32_32x32x16_bf16 v[192:207], v[84:87], v[84:87], 0
    v_mfma_f32_32x32x16_bf16 v[208:223], v[84:87], v[84:87], 0
    v_mfma_f32_32x32x16_bf16 v[224:239], v[84:87], v[84:87], 0
    s_lshl_b32 s62, s28, 2
    s_add_u32 s62, s62, s34
    s_mul_i32 s62, s62, 144
    s_lshl_b32 s63, s29, 1
    s_add_u32 s62, s62, s63
    s_add_u32 s62, s62, 112
    s_lshl_b32 s74, s62, 10
    v_mov_b32 v88, -1
    v_mov_b32 v89, -1
    v_mov_b32 v90, -1
    v_mov_b32 v91, -1
    s_mov_b32 s82, 0x3eb8aa3b
    s_mov_b32 s78, 0xbfb8aa3b
    s_mov_b32 s79, s78
    s_mov_b32 s80, 1.0
    s_mov_b32 s81, 1.0
    s_mov_b32 s47, 0
    s_mov_b32 s70, 6
    s_cmp_ge_u32 s100, 14
    s_cbranch_scc1 L_ckv
    s_mov_b32 s12, s52
    s_and_b32 s13, s53, 0xffff
    s_mov_b32 s14, 1835008
    s_mov_b32 s15, 0x00020000
    s_mov_b32 s16, s44
    s_and_b32 s17, s45, 0xffff
    s_mov_b32 s18, 524288
    s_mov_b32 s19, 0x00020000
    s_mov_b32 s20, s56
    s_and_b32 s21, s57, 0xffff
    s_mov_b32 s22, 2097152
    s_mov_b32 s23, 0x00020000
    s_mov_b32 s68, s101
    s_lshl_b32 s99, s35, 1
    s_add_u32 s99, s99, s33
    s_mul_i32 s62, s32, 14
    s_mul_i32 s74, s99, 144
    s_add_u32 s74, s74, s62
    s_lshl_b32 s74, s74, 10
    s_xor_b32 s63, s99, 1
    s_mul_i32 s63, s63, 144
    s_add_u32 s63, s63, s62
    s_lshl_b32 s63, s63, 10
    s_add_u32 s4, s8, s74
    s_addc_u32 s5, s9, 0
    s_mov_b32 s6, 14336
    s_add_u32 s24, s8, s63
    s_addc_u32 s25, s9, 0
    s_mov_b32 s26, 14336
    s_mov_b32 s74, 0
    s_mul_i32 s75, s32, 229376
    s_sub_u32 s75, s75, 24576
    s_lshl_b32 s62, s28, 2
    s_add_u32 s62, s62, s34
    s_xor_b32 s66, s62, 1
    s_and_b32 s63, s34, 1
    s_lshl_b32 s63, s63, 2
    s_lshl_b32 s64, s100, 3
    s_add_u32 s63, s63, s64
    s_mul_i32 s64, s62, 144
    s_add_u32 s64, s64, s63
    s_lshl_b32 s76, s64, 10
    s_mul_i32 s64, s66, 144
    s_add_u32 s64, s64, s63
    s_lshl_b32 s77, s64, 10
    s_mov_b32 s66, 4294868992
    s_mov_b32 s67, 49152
    s_mov_b32 s62, 4294964224
    s_mov_b32 s63, 1024
    s_barrier
    ds_read_b128 v[32:35], v245 offset:0
    ds_read_b64_tr_b16 v[64:65], v244 offset:0
    ds_read_b64_tr_b16 v[66:67], v244 offset:256
    ds_read_b128 v[36:39], v245 offset:2048
    ds_read_b64_tr_b16 v[68:69], v244 offset:32
    ds_read_b64_tr_b16 v[70:71], v244 offset:288
    ds_read_b64_tr_b16 v[72:73], v249 offset:0
    ds_read_b64_tr_b16 v[74:75], v249 offset:1024
    ds_read_b128 v[40:43], v240 offset:0
    ds_read_b128 v[44:47], v240 offset:2048
    ds_read_b64_tr_b16 v[76:77], v249 offset:16384
    ds_read_b64_tr_b16 v[78:79], v249 offset:17408
    s_branch L_ci
.p2align 6
L_cl:
    ds_read_b128 v[32:35], v245 offset:0
    ds_read_b64_tr_b16 v[64:65], v244 offset:0
    v_mfma_f32_16x16x32_bf16 v[188:191], v[72:75], v[60:63], v[188:191]
    ds_read_b64_tr_b16 v[66:67], v244 offset:256
    ds_read_b128 v[36:39], v245 offset:2048
    v_mfma_f32_16x16x32_bf16 v[192:195], v[76:79], v[48:51], v[192:195]
    ds_read_b64_tr_b16 v[68:69], v244 offset:32
    v_mfma_f32_16x16x32_bf16 v[196:199], v[76:79], v[52:55], v[196:199]
    ds_read_b64_tr_b16 v[70:71], v244 offset:288
    v_mfma_f32_16x16x32_bf16 v[200:203], v[76:79], v[56:59], v[200:203]
    ds_read_b64_tr_b16 v[72:73], v249 offset:0
    v_mfma_f32_16x16x32_bf16 v[204:207], v[76:79], v[60:63], v[204:207]
    ds_read_b64_tr_b16 v[74:75], v249 offset:1024
    v_mfma_f32_16x16x32_bf16 v[208:211], v[80:83], v[48:51], v[208:211]
    ds_read_b128 v[40:43], v240 offset:0
    v_mfma_f32_16x16x32_bf16 v[212:215], v[80:83], v[52:55], v[212:215]
    ds_read_b128 v[44:47], v240 offset:2048
    v_mfma_f32_16x16x32_bf16 v[216:219], v[80:83], v[56:59], v[216:219]
    ds_read_b64_tr_b16 v[76:77], v249 offset:16384
    v_mfma_f32_16x16x32_bf16 v[220:223], v[80:83], v[60:63], v[220:223]
    ds_read_b64_tr_b16 v[78:79], v249 offset:17408
L_ci:
    s_waitcnt lgkmcnt(9)
    v_mfma_f32_16x16x32_bf16 v[224:227], v[64:67], v[32:35], v[224:227]
    ds_read_b64_tr_b16 v[80:81], v250 offset:0
    s_waitcnt lgkmcnt(9)
    v_mfma_f32_16x16x32_bf16 v[228:231], v[64:67], v[36:39], v[228:231]
    ds_read_b64_tr_b16 v[82:83], v250 offset:1024
    s_waitcnt lgkmcnt(8)
    v_mfma_f32_16x16x32_bf16 v[232:235], v[68:71], v[32:35], v[232:235]
    ds_read_b64_tr_b16 v[64:65], v250 offset:16384
    v_mfma_f32_16x16x32_bf16 v[236:239], v[68:71], v[36:39], v[236:239]
    ds_read_b64_tr_b16 v[66:67], v250 offset:17408
    s_waitcnt lgkmcnt(8)
    v_mfma_f32_16x16x32_bf16 v[96:99], v[72:75], v[32:35], v[96:99]
    ds_read_b64_tr_b16 v[68:69], v251 offset:0
    v_mfma_f32_16x16x32_bf16 v[100:103], v[72:75], v[36:39], v[100:103]
    ds_read_b64_tr_b16 v[70:71], v251 offset:1024
    s_waitcnt lgkmcnt(9)
    v_mfma_f32_16x16x32_bf16 v[104:107], v[72:75], v[40:43], v[104:107]
    s_waitcnt lgkmcnt(8)
    v_mfma_f32_16x16x32_bf16 v[108:111], v[72:75], v[44:47], v[108:111]
    s_waitcnt lgkmcnt(6)
    v_mfma_f32_16x16x32_bf16 v[112:115], v[76:79], v[32:35], v[112:115]
    ds_read_b64_tr_b16 v[72:73], v251 offset:16384
    v_mfma_f32_16x16x32_bf16 v[116:119], v[76:79], v[36:39], v[116:119]
    ds_read_b64_tr_b16 v[74:75], v251 offset:17408
    v_mfma_f32_16x16x32_bf16 v[120:123], v[76:79], v[40:43], v[120:123]
    s_cmp_eq_u32 s47, 98304
    s_cselect_b32 s65, s66, s67
    v_mfma_f32_16x16x32_bf16 v[124:127], v[76:79], v[44:47], v[124:127]
    s_add_u32 s47, s47, s65
    s_waitcnt lgkmcnt(6)
    v_mfma_f32_16x16x32_bf16 v[128:131], v[80:83], v[32:35], v[128:131]
    ds_read_b64_tr_b16 v[76:77], v252 offset:0
    v_mfma_f32_16x16x32_bf16 v[132:135], v[80:83], v[36:39], v[132:135]
    ds_read_b64_tr_b16 v[78:79], v252 offset:1024
    v_mfma_f32_16x16x32_bf16 v[136:139], v[80:83], v[40:43], v[136:139]
    ds_read_b128 v[48:51], v246 offset:0
    v_mfma_f32_16x16x32_bf16 v[140:143], v[80:83], v[44:47], v[140:143]
    v_add_u32 v245, s65, v245
    s_waitcnt lgkmcnt(7)
    v_mfma_f32_16x16x32_bf16 v[144:147], v[64:67], v[32:35], v[144:147]
    ds_read_b64_tr_b16 v[80:81], v252 offset:16384
    v_mfma_f32_16x16x32_bf16 v[148:151], v[64:67], v[36:39], v[148:151]
    ds_read_b64_tr_b16 v[82:83], v252 offset:17408
    v_mfma_f32_16x16x32_bf16 v[152:155], v[64:67], v[40:43], v[152:155]
    ds_read_b128 v[52:55], v246 offset:2048
    v_mfma_f32_16x16x32_bf16 v[156:159], v[64:67], v[44:47], v[156:159]
    v_add_u32 v240, s65, v240
    s_waitcnt lgkmcnt(8)
    v_mfma_f32_16x16x32_bf16 v[160:163], v[68:71], v[32:35], v[160:163]
    ds_read_b64_tr_b16 v[64:65], v244 offset:8192
    v_mfma_f32_16x16x32_bf16 v[164:167], v[68:71], v[36:39], v[164:167]
    ds_read_b64_tr_b16 v[66:67], v244 offset:8448
    v_mfma_f32_16x16x32_bf16 v[168:171], v[68:71], v[40:43], v[168:171]
    ds_read_b128 v[56:59], v241 offset:0
    v_mfma_f32_16x16x32_bf16 v[172:175], v[68:71], v[44:47], v[172:175]
    s_cmp_eq_u32 s70, 3
    s_waitcnt lgkmcnt(9)
    v_mfma_f32_16x16x32_bf16 v[176:179], v[72:75], v[32:35], v[176:179]
    ds_read_b64_tr_b16 v[68:69], v244 offset:8224
    v_mfma_f32_16x16x32_bf16 v[180:183], v[72:75], v[36:39], v[180:183]
    ds_read_b64_tr_b16 v[70:71], v244 offset:8480
    v_mfma_f32_16x16x32_bf16 v[184:187], v[72:75], v[40:43], v[184:187]
    ds_read_b128 v[60:63], v241 offset:2048
    v_mfma_f32_16x16x32_bf16 v[188:191], v[72:75], v[44:47], v[188:191]
    s_cselect_b32 s83, s62, s63
    s_waitcnt lgkmcnt(10)
    v_mfma_f32_16x16x32_bf16 v[192:195], v[76:79], v[32:35], v[192:195]
    ds_read_b64_tr_b16 v[72:73], v249 offset:8192
    v_mfma_f32_16x16x32_bf16 v[196:199], v[76:79], v[36:39], v[196:199]
    ds_read_b64_tr_b16 v[74:75], v249 offset:9216
    v_mfma_f32_16x16x32_bf16 v[200:203], v[76:79], v[40:43], v[200:203]
    v_add_u32 v246, s65, v246
    v_add_u32 v241, s65, v241
    v_mfma_f32_16x16x32_bf16 v[204:207], v[76:79], v[44:47], v[204:207]
    v_add_u32 v244, s83, v244
    s_waitcnt lgkmcnt(9)
    v_mfma_f32_16x16x32_bf16 v[208:211], v[80:83], v[32:35], v[208:211]
    ds_read_b64_tr_b16 v[76:77], v249 offset:24576
    v_mfma_f32_16x16x32_bf16 v[212:215], v[80:83], v[36:39], v[212:215]
    ds_read_b64_tr_b16 v[78:79], v249 offset:25600
    v_mfma_f32_16x16x32_bf16 v[216:219], v[80:83], v[40:43], v[216:219]
    v_add_u32 v249, s65, v249
    v_mfma_f32_16x16x32_bf16 v[220:223], v[80:83], v[44:47], v[220:223]
    s_waitcnt lgkmcnt(8)
    v_mfma_f32_16x16x32_bf16 v[224:227], v[64:67], v[48:51], v[224:227]
    ds_read_b64_tr_b16 v[80:81], v250 offset:8192
    v_mfma_f32_16x16x32_bf16 v[228:231], v[64:67], v[52:55], v[228:231]
    ds_read_b64_tr_b16 v[82:83], v250 offset:9216
    s_waitcnt lgkmcnt(7)
    v_mfma_f32_16x16x32_bf16 v[232:235], v[68:71], v[48:51], v[232:235]
    ds_read_b64_tr_b16 v[64:65], v250 offset:24576
    v_mfma_f32_16x16x32_bf16 v[236:239], v[68:71], v[52:55], v[236:239]
    ds_read_b64_tr_b16 v[66:67], v250 offset:25600
    s_waitcnt lgkmcnt(6)
    v_mfma_f32_16x16x32_bf16 v[96:99], v[72:75], v[48:51], v[96:99]
    ds_read_b64_tr_b16 v[68:69], v251 offset:8192
    v_mfma_f32_16x16x32_bf16 v[100:103], v[72:75], v[52:55], v[100:103]
    ds_read_b64_tr_b16 v[70:71], v251 offset:9216
    v_mfma_f32_16x16x32_bf16 v[104:107], v[72:75], v[56:59], v[104:107]
    v_add_u32 v250, s65, v250
    v_mfma_f32_16x16x32_bf16 v[108:111], v[72:75], v[60:63], v[108:111]
    s_waitcnt lgkmcnt(6)
    v_mfma_f32_16x16x32_bf16 v[112:115], v[76:79], v[48:51], v[112:115]
    ds_read_b64_tr_b16 v[72:73], v251 offset:24576
    v_mfma_f32_16x16x32_bf16 v[116:119], v[76:79], v[52:55], v[116:119]
    ds_read_b64_tr_b16 v[74:75], v251 offset:25600
    v_mfma_f32_16x16x32_bf16 v[120:123], v[76:79], v[56:59], v[120:123]
    v_add_u32 v251, s65, v251
    v_mfma_f32_16x16x32_bf16 v[124:127], v[76:79], v[60:63], v[124:127]
    s_waitcnt lgkmcnt(6)
    v_mfma_f32_16x16x32_bf16 v[128:131], v[80:83], v[48:51], v[128:131]
    ds_read_b64_tr_b16 v[76:77], v252 offset:8192
    v_mfma_f32_16x16x32_bf16 v[132:135], v[80:83], v[52:55], v[132:135]
    ds_read_b64_tr_b16 v[78:79], v252 offset:9216
    v_mfma_f32_16x16x32_bf16 v[136:139], v[80:83], v[56:59], v[136:139]
    v_mfma_f32_16x16x32_bf16 v[140:143], v[80:83], v[60:63], v[140:143]
    s_waitcnt lgkmcnt(6)
    v_mfma_f32_16x16x32_bf16 v[144:147], v[64:67], v[48:51], v[144:147]
    ds_read_b64_tr_b16 v[80:81], v252 offset:24576
    v_mfma_f32_16x16x32_bf16 v[148:151], v[64:67], v[52:55], v[148:151]
    ds_read_b64_tr_b16 v[82:83], v252 offset:25600
    v_mfma_f32_16x16x32_bf16 v[152:155], v[64:67], v[56:59], v[152:155]
    v_add_u32 v252, s65, v252
    v_mfma_f32_16x16x32_bf16 v[156:159], v[64:67], v[60:63], v[156:159]
    s_waitcnt lgkmcnt(6)
    v_mfma_f32_16x16x32_bf16 v[160:163], v[68:71], v[48:51], v[160:163]
    s_sub_u32 s70, s70, 1
    v_mfma_f32_16x16x32_bf16 v[164:167], v[68:71], v[52:55], v[164:167]
    v_mfma_f32_16x16x32_bf16 v[168:171], v[68:71], v[56:59], v[168:171]
    v_mfma_f32_16x16x32_bf16 v[172:175], v[68:71], v[60:63], v[172:175]
    s_waitcnt lgkmcnt(4)
    v_mfma_f32_16x16x32_bf16 v[176:179], v[72:75], v[48:51], v[176:179]
    v_mfma_f32_16x16x32_bf16 v[180:183], v[72:75], v[52:55], v[180:183]
    s_waitcnt lgkmcnt(0)
    s_barrier
    v_mfma_f32_16x16x32_bf16 v[184:187], v[72:75], v[56:59], v[184:187]
    s_cbranch_scc0 L_cl
L_last:
    ds_read_b128 v[32:35], v245 offset:0
    ds_read_b64_tr_b16 v[64:65], v244 offset:0
    v_mfma_f32_16x16x32_bf16 v[188:191], v[72:75], v[60:63], v[188:191]
    ds_read_b64_tr_b16 v[66:67], v244 offset:256
    ds_read_b128 v[36:39], v245 offset:2048
    v_mfma_f32_16x16x32_bf16 v[192:195], v[76:79], v[48:51], v[192:195]
    ds_read_b64_tr_b16 v[68:69], v244 offset:32
    v_mfma_f32_16x16x32_bf16 v[196:199], v[76:79], v[52:55], v[196:199]
    ds_read_b64_tr_b16 v[70:71], v244 offset:288
    v_mfma_f32_16x16x32_bf16 v[200:203], v[76:79], v[56:59], v[200:203]
    ds_read_b64_tr_b16 v[72:73], v249 offset:0
    v_mfma_f32_16x16x32_bf16 v[204:207], v[76:79], v[60:63], v[204:207]
    ds_read_b64_tr_b16 v[74:75], v249 offset:1024
    v_mfma_f32_16x16x32_bf16 v[208:211], v[80:83], v[48:51], v[208:211]
    ds_read_b128 v[40:43], v240 offset:0
    v_mfma_f32_16x16x32_bf16 v[212:215], v[80:83], v[52:55], v[212:215]
    ds_read_b128 v[44:47], v240 offset:2048
    v_mfma_f32_16x16x32_bf16 v[216:219], v[80:83], v[56:59], v[216:219]
    ds_read_b64_tr_b16 v[76:77], v249 offset:16384
    v_mfma_f32_16x16x32_bf16 v[220:223], v[80:83], v[60:63], v[220:223]
    ds_read_b64_tr_b16 v[78:79], v249 offset:17408
    s_waitcnt lgkmcnt(9)
    v_mfma_f32_16x16x32_bf16 v[224:227], v[64:67], v[32:35], v[224:227]
    ds_read_b64_tr_b16 v[80:81], v250 offset:0
    s_waitcnt lgkmcnt(9)
    v_mfma_f32_16x16x32_bf16 v[228:231], v[64:67], v[36:39], v[228:231]
    ds_read_b64_tr_b16 v[82:83], v250 offset:1024
    s_waitcnt lgkmcnt(8)
    v_mfma_f32_16x16x32_bf16 v[232:235], v[68:71], v[32:35], v[232:235]
    ds_read_b64_tr_b16 v[64:65], v250 offset:16384
    v_mfma_f32_16x16x32_bf16 v[236:239], v[68:71], v[36:39], v[236:239]
    ds_read_b64_tr_b16 v[66:67], v250 offset:17408
    s_waitcnt lgkmcnt(8)
    v_mfma_f32_16x16x32_bf16 v[96:99], v[72:75], v[32:35], v[96:99]
    ds_read_b64_tr_b16 v[68:69], v244 offset:8192
    v_mfma_f32_16x16x32_bf16 v[100:103], v[72:75], v[36:39], v[100:103]
    ds_read_b64_tr_b16 v[70:71], v244 offset:8448
    s_waitcnt lgkmcnt(9)
    v_mfma_f32_16x16x32_bf16 v[104:107], v[72:75], v[40:43], v[104:107]
    ds_read_b128 v[48:51], v246 offset:0
    s_waitcnt lgkmcnt(9)
    v_mfma_f32_16x16x32_bf16 v[108:111], v[72:75], v[44:47], v[108:111]
    s_waitcnt lgkmcnt(7)
    v_mfma_f32_16x16x32_bf16 v[112:115], v[76:79], v[32:35], v[112:115]
    ds_read_b64_tr_b16 v[72:73], v244 offset:8224
    v_mfma_f32_16x16x32_bf16 v[116:119], v[76:79], v[36:39], v[116:119]
    ds_read_b64_tr_b16 v[74:75], v244 offset:8480
    v_mfma_f32_16x16x32_bf16 v[120:123], v[76:79], v[40:43], v[120:123]
    ds_read_b128 v[52:55], v246 offset:2048
    v_mfma_f32_16x16x32_bf16 v[124:127], v[76:79], v[44:47], v[124:127]
    s_waitcnt lgkmcnt(8)
    v_mfma_f32_16x16x32_bf16 v[128:131], v[80:83], v[32:35], v[128:131]
    ds_read_b64_tr_b16 v[76:77], v251 offset:0
    v_mfma_f32_16x16x32_bf16 v[132:135], v[80:83], v[36:39], v[132:135]
    ds_read_b64_tr_b16 v[78:79], v251 offset:1024
    v_mfma_f32_16x16x32_bf16 v[136:139], v[80:83], v[40:43], v[136:139]
    ds_read_b128 v[56:59], v241 offset:0
    v_mfma_f32_16x16x32_bf16 v[140:143], v[80:83], v[44:47], v[140:143]
    s_waitcnt lgkmcnt(9)
    v_mfma_f32_16x16x32_bf16 v[144:147], v[64:67], v[32:35], v[144:147]
    ds_read_b64_tr_b16 v[80:81], v251 offset:16384
    v_mfma_f32_16x16x32_bf16 v[148:151], v[64:67], v[36:39], v[148:151]
    ds_read_b64_tr_b16 v[82:83], v251 offset:17408
    v_mfma_f32_16x16x32_bf16 v[152:155], v[64:67], v[40:43], v[152:155]
    ds_read_b128 v[60:63], v241 offset:2048
    v_mfma_f32_16x16x32_bf16 v[156:159], v[64:67], v[44:47], v[156:159]
    s_waitcnt lgkmcnt(9)
    v_mfma_f32_16x16x32_bf16 v[224:227], v[68:71], v[48:51], v[224:227]
    ds_read_b64_tr_b16 v[64:65], v252 offset:0
    s_waitcnt lgkmcnt(7)
    v_mfma_f32_16x16x32_bf16 v[228:231], v[68:71], v[52:55], v[228:231]
    ds_read_b64_tr_b16 v[66:67], v252 offset:1024
    v_mfma_f32_16x16x32_bf16 v[232:235], v[72:75], v[48:51], v[232:235]
    ds_read_b64_tr_b16 v[68:69], v252 offset:16384
    v_mfma_f32_16x16x32_bf16 v[236:239], v[72:75], v[52:55], v[236:239]
    ds_read_b64_tr_b16 v[70:71], v252 offset:17408
    s_waitcnt lgkmcnt(8)
    v_mfma_f32_16x16x32_bf16 v[160:163], v[76:79], v[32:35], v[160:163]
    ds_read_b64_tr_b16 v[72:73], v249 offset:8192
    v_mfma_f32_16x16x32_bf16 v[164:167], v[76:79], v[36:39], v[164:167]
    ds_read_b64_tr_b16 v[74:75], v249 offset:9216
    v_mfma_f32_16x16x32_bf16 v[168:171], v[76:79], v[40:43], v[168:171]
    v_mfma_f32_16x16x32_bf16 v[172:175], v[76:79], v[44:47], v[172:175]
    s_waitcnt lgkmcnt(7)
    v_mfma_f32_16x16x32_bf16 v[176:179], v[80:83], v[32:35], v[176:179]
    ds_read_b64_tr_b16 v[76:77], v249 offset:24576
    v_mfma_f32_16x16x32_bf16 v[180:183], v[80:83], v[36:39], v[180:183]
    ds_read_b64_tr_b16 v[78:79], v249 offset:25600
    v_mfma_f32_16x16x32_bf16 v[184:187], v[80:83], v[40:43], v[184:187]
    v_mul_f32 v224, s82, v224
    v_mul_f32 v225, s82, v225
    v_mfma_f32_16x16x32_bf16 v[188:191], v[80:83], v[44:47], v[188:191]
    v_mul_f32 v226, s82, v226
    v_mul_f32 v227, s82, v227
    s_waitcnt lgkmcnt(6)
    v_mfma_f32_16x16x32_bf16 v[192:195], v[64:67], v[32:35], v[192:195]
    ds_read_b64_tr_b16 v[80:81], v250 offset:8192
    v_mul_f32 v228, s82, v228
    v_mfma_f32_16x16x32_bf16 v[196:199], v[64:67], v[36:39], v[196:199]
    ds_read_b64_tr_b16 v[82:83], v250 offset:9216
    v_mul_f32 v229, s82, v229
    v_mfma_f32_16x16x32_bf16 v[200:203], v[64:67], v[40:43], v[200:203]
    v_mul_f32 v230, s82, v230
    v_mul_f32 v231, s82, v231
    v_mfma_f32_16x16x32_bf16 v[204:207], v[64:67], v[44:47], v[204:207]
    v_mul_f32 v232, s82, v232
    v_mul_f32 v233, s82, v233
    s_waitcnt lgkmcnt(6)
    v_mfma_f32_16x16x32_bf16 v[208:211], v[68:71], v[32:35], v[208:211]
    ds_read_b64_tr_b16 v[64:65], v250 offset:24576
    v_mul_f32 v234, s82, v234
    v_mfma_f32_16x16x32_bf16 v[212:215], v[68:71], v[36:39], v[212:215]
    ds_read_b64_tr_b16 v[66:67], v250 offset:25600
    v_mul_f32 v235, s82, v235
    v_mfma_f32_16x16x32_bf16 v[216:219], v[68:71], v[40:43], v[216:219]
    v_mul_f32 v236, s82, v236
    v_mul_f32 v237, s82, v237
    v_mfma_f32_16x16x32_bf16 v[220:223], v[68:71], v[44:47], v[220:223]
    v_mul_f32 v238, s82, v238
    v_mul_f32 v239, s82, v239
    s_waitcnt lgkmcnt(6)
    v_mfma_f32_16x16x32_bf16 v[96:99], v[72:75], v[48:51], v[96:99]
    ds_read_b64_tr_b16 v[68:69], v251 offset:8192
    v_cvt_pk_bf16_f32 v88, v224, v225
    v_mfma_f32_16x16x32_bf16 v[100:103], v[72:75], v[52:55], v[100:103]
    ds_read_b64_tr_b16 v[70:71], v251 offset:9216
    v_cvt_pk_bf16_f32 v89, v226, v227
    v_mfma_f32_16x16x32_bf16 v[104:107], v[72:75], v[56:59], v[104:107]
    v_cvt_pk_bf16_f32 v90, v228, v229
    v_cvt_pk_bf16_f32 v91, v230, v231
    v_mfma_f32_16x16x32_bf16 v[108:111], v[72:75], v[60:63], v[108:111]
    v_cvt_pk_bf16_f32 v92, v232, v233
    v_cvt_pk_bf16_f32 v93, v234, v235
    s_waitcnt lgkmcnt(6)
    v_mfma_f32_16x16x32_bf16 v[112:115], v[76:79], v[48:51], v[112:115]
    ds_read_b64_tr_b16 v[72:73], v251 offset:24576
    v_cvt_pk_bf16_f32 v94, v236, v237
    v_mfma_f32_16x16x32_bf16 v[116:119], v[76:79], v[52:55], v[116:119]
    ds_read_b64_tr_b16 v[74:75], v251 offset:25600
    v_cvt_pk_bf16_f32 v95, v238, v239
    v_mfma_f32_16x16x32_bf16 v[120:123], v[76:79], v[56:59], v[120:123]
    ds_write_b64 v242, v[88:89] offset:1024
    ds_write_b64 v242, v[90:91] offset:1280
    v_mfma_f32_16x16x32_bf16 v[124:127], v[76:79], v[60:63], v[124:127]
    ds_write_b64 v242, v[92:93] offset:0
    ds_write_b64 v242, v[94:95] offset:256
    s_waitcnt lgkmcnt(10)
    v_mfma_f32_16x16x32_bf16 v[128:131], v[80:83], v[48:51], v[128:131]
    ds_read_b64_tr_b16 v[76:77], v252 offset:8192
    v_mfma_f32_16x16x32_bf16 v[132:135], v[80:83], v[52:55], v[132:135]
    ds_read_b64_tr_b16 v[78:79], v252 offset:9216
    v_mfma_f32_16x16x32_bf16 v[136:139], v[80:83], v[56:59], v[136:139]
    v_mfma_f32_16x16x32_bf16 v[140:143], v[80:83], v[60:63], v[140:143]
    s_waitcnt lgkmcnt(10)
    v_mfma_f32_16x16x32_bf16 v[144:147], v[64:67], v[48:51], v[144:147]
    ds_read_b64_tr_b16 v[80:81], v252 offset:24576
    s_waitcnt lgkmcnt(3)
    v_mfma_f32_16x16x32_bf16 v[148:151], v[64:67], v[52:55], v[148:151]
    ds_read_b64_tr_b16 v[82:83], v252 offset:25600
    ds_read_b128 v[8:11], v16 offset:1024
    v_mfma_f32_16x16x32_bf16 v[152:155], v[64:67], v[56:59], v[152:155]
    ds_read_b128 v[12:15], v16
    v_mfma_f32_16x16x32_bf16 v[156:159], v[64:67], v[60:63], v[156:159]
    v_mfma_f32_16x16x32_bf16 v[160:163], v[68:71], v[48:51], v[160:163]
    v_mfma_f32_16x16x32_bf16 v[164:167], v[68:71], v[52:55], v[164:167]
    v_mfma_f32_16x16x32_bf16 v[168:171], v[68:71], v[56:59], v[168:171]
    v_mfma_f32_16x16x32_bf16 v[172:175], v[68:71], v[60:63], v[172:175]
    v_mfma_f32_16x16x32_bf16 v[176:179], v[72:75], v[48:51], v[176:179]
    v_mfma_f32_16x16x32_bf16 v[180:183], v[72:75], v[52:55], v[180:183]
    s_waitcnt lgkmcnt(0)
    s_barrier
    s_setprio 2
    v_mfma_f32_16x16x32_bf16 v[184:187], v[72:75], v[56:59], v[184:187]
    v_mfma_f32_16x16x32_bf16 v[188:191], v[72:75], v[60:63], v[188:191]
    v_mfma_f32_16x16x32_bf16 v[192:195], v[76:79], v[48:51], v[192:195]
    v_pk_mul_f32 v[96:97], v[96:97], s[78:79]
    v_pk_mul_f32 v[98:99], v[98:99], s[78:79]
    v_pk_mul_f32 v[128:129], v[128:129], s[78:79]
    v_pk_mul_f32 v[130:131], v[130:131], s[78:79]
    v_mfma_f32_16x16x32_bf16 v[196:199], v[76:79], v[52:55], v[196:199]
    v_exp_f32 v96, v96
    v_exp_f32 v97, v97
    v_exp_f32 v98, v98
    v_exp_f32 v99, v99
    v_mfma_f32_16x16x32_bf16 v[200:203], v[76:79], v[56:59], v[200:203]
    v_exp_f32 v128, v128
    v_exp_f32 v129, v129
    v_exp_f32 v130, v130
    v_exp_f32 v131, v131
    v_mfma_f32_16x16x32_bf16 v[204:207], v[76:79], v[60:63], v[204:207]
    v_pk_add_f32 v[96:97], v[96:97], s[80:81]
    v_pk_add_f32 v[98:99], v[98:99], s[80:81]
    v_pk_add_f32 v[128:129], v[128:129], s[80:81]
    v_pk_add_f32 v[130:131], v[130:131], s[80:81]
    v_mfma_f32_16x16x32_bf16 v[208:211], v[80:83], v[48:51], v[208:211]
    v_rcp_f32 v96, v96
    v_rcp_f32 v97, v97
    v_rcp_f32 v98, v98
    v_rcp_f32 v99, v99
    v_mfma_f32_16x16x32_bf16 v[212:215], v[80:83], v[52:55], v[212:215]
    v_rcp_f32 v128, v128
    v_rcp_f32 v129, v129
    v_rcp_f32 v130, v130
    v_rcp_f32 v131, v131
    v_mfma_f32_16x16x32_bf16 v[216:219], v[80:83], v[56:59], v[216:219]
    v_pk_mul_f32 v[96:97], v[96:97], v[112:113]
    v_pk_mul_f32 v[98:99], v[98:99], v[114:115]
    v_pk_mul_f32 v[128:129], v[128:129], v[144:145]
    v_pk_mul_f32 v[130:131], v[130:131], v[146:147]
    v_mfma_f32_16x16x32_bf16 v[220:223], v[80:83], v[60:63], v[220:223]
    v_cvt_pk_bf16_f32 v224, v96, v97
    v_cvt_pk_bf16_f32 v225, v98, v99
    v_cvt_pk_bf16_f32 v226, v128, v129
    v_cvt_pk_bf16_f32 v227, v130, v131
    v_mov_b32 v56, 0
    v_mov_b32 v57, 0
    v_mov_b32 v58, 0
    v_mov_b32 v59, 0
    v_mov_b32 v60, 0
    v_mov_b32 v61, 0
    v_mov_b32 v62, 0
    v_mov_b32 v63, 0
    v_mfma_f32_32x32x16_bf16 v[64:79], v[56:59], v[56:59], 0
    v_mfma_f32_32x32x16_bf16 v[80:95], v[56:59], v[56:59], 0
    v_pk_mul_f32 v[100:101], v[100:101], s[78:79]
    v_pk_mul_f32 v[102:103], v[102:103], s[78:79]
    v_pk_mul_f32 v[132:133], v[132:133], s[78:79]
    v_pk_mul_f32 v[134:135], v[134:135], s[78:79]
    v_exp_f32 v100, v100
    v_exp_f32 v101, v101
    v_exp_f32 v102, v102
    v_exp_f32 v103, v103
    v_exp_f32 v132, v132
    v_exp_f32 v133, v133
    v_exp_f32 v134, v134
    v_exp_f32 v135, v135
    v_pk_add_f32 v[100:101], v[100:101], s[80:81]
    v_pk_add_f32 v[102:103], v[102:103], s[80:81]
    v_pk_add_f32 v[132:133], v[132:133], s[80:81]
    v_pk_add_f32 v[134:135], v[134:135], s[80:81]
    v_rcp_f32 v100, v100
    v_rcp_f32 v101, v101
    v_rcp_f32 v102, v102
    v_rcp_f32 v103, v103
    v_rcp_f32 v132, v132
    v_rcp_f32 v133, v133
    v_rcp_f32 v134, v134
    v_rcp_f32 v135, v135
    v_pk_mul_f32 v[100:101], v[100:101], v[116:117]
    v_pk_mul_f32 v[102:103], v[102:103], v[118:119]
    v_pk_mul_f32 v[132:133], v[132:133], v[148:149]
    v_pk_mul_f32 v[134:135], v[134:135], v[150:151]
    v_cvt_pk_bf16_f32 v228, v100, v101
    v_cvt_pk_bf16_f32 v229, v102, v103
    v_cvt_pk_bf16_f32 v230, v132, v133
    v_cvt_pk_bf16_f32 v231, v134, v135
    v_pk_mul_f32 v[104:105], v[104:105], s[78:79]
    v_pk_mul_f32 v[106:107], v[106:107], s[78:79]
    v_pk_mul_f32 v[136:137], v[136:137], s[78:79]
    v_pk_mul_f32 v[138:139], v[138:139], s[78:79]
    v_exp_f32 v104, v104
    v_exp_f32 v105, v105
    v_exp_f32 v106, v106
    v_exp_f32 v107, v107
    v_exp_f32 v136, v136
    v_exp_f32 v137, v137
    v_exp_f32 v138, v138
    v_exp_f32 v139, v139
    v_pk_add_f32 v[104:105], v[104:105], s[80:81]
    v_pk_add_f32 v[106:107], v[106:107], s[80:81]
    v_pk_add_f32 v[136:137], v[136:137], s[80:81]
    v_pk_add_f32 v[138:139], v[138:139], s[80:81]
    v_rcp_f32 v104, v104
    v_rcp_f32 v105, v105
    v_rcp_f32 v106, v106
    v_rcp_f32 v107, v107
    v_rcp_f32 v136, v136
    v_rcp_f32 v137, v137
    v_rcp_f32 v138, v138
    v_rcp_f32 v139, v139
    v_pk_mul_f32 v[104:105], v[104:105], v[120:121]
    v_pk_mul_f32 v[106:107], v[106:107], v[122:123]
    v_pk_mul_f32 v[136:137], v[136:137], v[152:153]
    v_pk_mul_f32 v[138:139], v[138:139], v[154:155]
    v_cvt_pk_bf16_f32 v232, v104, v105
    v_cvt_pk_bf16_f32 v233, v106, v107
    v_cvt_pk_bf16_f32 v234, v136, v137
    v_cvt_pk_bf16_f32 v235, v138, v139
    v_pk_mul_f32 v[108:109], v[108:109], s[78:79]
    v_pk_mul_f32 v[110:111], v[110:111], s[78:79]
    v_pk_mul_f32 v[140:141], v[140:141], s[78:79]
    v_pk_mul_f32 v[142:143], v[142:143], s[78:79]
    v_exp_f32 v108, v108
    v_exp_f32 v109, v109
    v_exp_f32 v110, v110
    v_exp_f32 v111, v111
    v_exp_f32 v140, v140
    v_exp_f32 v141, v141
    v_exp_f32 v142, v142
    v_exp_f32 v143, v143
    v_pk_add_f32 v[108:109], v[108:109], s[80:81]
    v_pk_add_f32 v[110:111], v[110:111], s[80:81]
    v_pk_add_f32 v[140:141], v[140:141], s[80:81]
    v_pk_add_f32 v[142:143], v[142:143], s[80:81]
    v_rcp_f32 v108, v108
    v_rcp_f32 v109, v109
    v_rcp_f32 v110, v110
    v_rcp_f32 v111, v111
    v_rcp_f32 v140, v140
    v_rcp_f32 v141, v141
    v_rcp_f32 v142, v142
    v_rcp_f32 v143, v143
    v_pk_mul_f32 v[108:109], v[108:109], v[124:125]
    v_pk_mul_f32 v[110:111], v[110:111], v[126:127]
    v_pk_mul_f32 v[140:141], v[140:141], v[156:157]
    v_pk_mul_f32 v[142:143], v[142:143], v[158:159]
    v_cvt_pk_bf16_f32 v236, v108, v109
    v_cvt_pk_bf16_f32 v237, v110, v111
    v_cvt_pk_bf16_f32 v238, v140, v141
    v_cvt_pk_bf16_f32 v239, v142, v143
    v_mov_b32 v104, v26
    v_mov_b32 v105, v26
    v_mov_b32 v106, v26
    v_mov_b32 v107, v26
    v_mov_b32 v108, v26
    v_mov_b32 v109, v26
    v_mov_b32 v110, v26
    v_mov_b32 v111, v26
    v_mov_b32 v112, v26
    v_mov_b32 v113, v26
    v_mov_b32 v114, v26
    v_mov_b32 v115, v26
    v_mov_b32 v116, v26
    v_mov_b32 v117, v26
    v_mov_b32 v118, v26
    v_mov_b32 v119, v26
    v_add_u32 v120, 15360, v24
    v_add_u32 v121, 7168, v24
    v_pk_mul_f32 v[160:161], v[160:161], s[78:79]
    v_pk_mul_f32 v[162:163], v[162:163], s[78:79]
    v_pk_mul_f32 v[192:193], v[192:193], s[78:79]
    v_pk_mul_f32 v[194:195], v[194:195], s[78:79]
    v_exp_f32 v160, v160
    v_exp_f32 v161, v161
    v_exp_f32 v162, v162
    v_exp_f32 v163, v163
    v_exp_f32 v192, v192
    v_exp_f32 v193, v193
    v_exp_f32 v194, v194
    v_exp_f32 v195, v195
    v_pk_add_f32 v[160:161], v[160:161], s[80:81]
    v_pk_add_f32 v[162:163], v[162:163], s[80:81]
    v_pk_add_f32 v[192:193], v[192:193], s[80:81]
    v_pk_add_f32 v[194:195], v[194:195], s[80:81]
    v_rcp_f32 v160, v160
    v_rcp_f32 v161, v161
    v_rcp_f32 v162, v162
    v_rcp_f32 v163, v163
    v_rcp_f32 v192, v192
    v_rcp_f32 v193, v193
    v_rcp_f32 v194, v194
    v_rcp_f32 v195, v195
    v_pk_mul_f32 v[160:161], v[160:161], v[176:177]
    v_pk_mul_f32 v[162:163], v[162:163], v[178:179]
    v_pk_mul_f32 v[192:193], v[192:193], v[208:209]
    v_pk_mul_f32 v[194:195], v[194:195], v[210:211]
    v_cvt_pk_bf16_f32 v240, v160, v161
    v_cvt_pk_bf16_f32 v241, v162, v163
    v_cvt_pk_bf16_f32 v242, v192, v193
    v_cvt_pk_bf16_f32 v243, v194, v195
    v_pk_mul_f32 v[164:165], v[164:165], s[78:79]
    v_pk_mul_f32 v[166:167], v[166:167], s[78:79]
    v_pk_mul_f32 v[196:197], v[196:197], s[78:79]
    v_pk_mul_f32 v[198:199], v[198:199], s[78:79]
    v_exp_f32 v164, v164
    v_exp_f32 v165, v165
    v_exp_f32 v166, v166
    v_exp_f32 v167, v167
    v_exp_f32 v196, v196
    v_exp_f32 v197, v197
    v_exp_f32 v198, v198
    v_exp_f32 v199, v199
    v_pk_add_f32 v[164:165], v[164:165], s[80:81]
    v_pk_add_f32 v[166:167], v[166:167], s[80:81]
    v_pk_add_f32 v[196:197], v[196:197], s[80:81]
    v_pk_add_f32 v[198:199], v[198:199], s[80:81]
    v_rcp_f32 v164, v164
    v_rcp_f32 v165, v165
    v_rcp_f32 v166, v166
    v_rcp_f32 v167, v167
    v_rcp_f32 v196, v196
    v_rcp_f32 v197, v197
    v_rcp_f32 v198, v198
    v_rcp_f32 v199, v199
    v_pk_mul_f32 v[164:165], v[164:165], v[180:181]
    v_pk_mul_f32 v[166:167], v[166:167], v[182:183]
    v_pk_mul_f32 v[196:197], v[196:197], v[212:213]
    v_pk_mul_f32 v[198:199], v[198:199], v[214:215]
    v_cvt_pk_bf16_f32 v244, v164, v165
    v_cvt_pk_bf16_f32 v245, v166, v167
    v_cvt_pk_bf16_f32 v246, v196, v197
    v_cvt_pk_bf16_f32 v247, v198, v199
    s_barrier
    ds_read_b128 v[96:99], v20
    s_mov_b64 exec, s[72:73]
    ds_read_b128 v[104:107], v21
    ds_read_b128 v[108:111], v21 offset:512
    s_mov_b64 exec, -1
    v_pk_mul_f32 v[168:169], v[168:169], s[78:79]
    v_pk_mul_f32 v[170:171], v[170:171], s[78:79]
    v_pk_mul_f32 v[200:201], v[200:201], s[78:79]
    v_pk_mul_f32 v[202:203], v[202:203], s[78:79]
    v_exp_f32 v168, v168
    v_exp_f32 v169, v169
    v_exp_f32 v170, v170
    v_exp_f32 v171, v171
    v_exp_f32 v200, v200
    v_exp_f32 v201, v201
    v_exp_f32 v202, v202
    v_exp_f32 v203, v203
    v_pk_add_f32 v[168:169], v[168:169], s[80:81]
    v_pk_add_f32 v[170:171], v[170:171], s[80:81]
    v_pk_add_f32 v[200:201], v[200:201], s[80:81]
    v_pk_add_f32 v[202:203], v[202:203], s[80:81]
    v_rcp_f32 v168, v168
    v_rcp_f32 v169, v169
    v_rcp_f32 v170, v170
    v_rcp_f32 v171, v171
    v_rcp_f32 v200, v200
    v_rcp_f32 v201, v201
    v_rcp_f32 v202, v202
    v_rcp_f32 v203, v203
    v_pk_mul_f32 v[168:169], v[168:169], v[184:185]
    v_pk_mul_f32 v[170:171], v[170:171], v[186:187]
    v_pk_mul_f32 v[200:201], v[200:201], v[216:217]
    v_pk_mul_f32 v[202:203], v[202:203], v[218:219]
    v_cvt_pk_bf16_f32 v248, v168, v169
    v_cvt_pk_bf16_f32 v249, v170, v171
    v_cvt_pk_bf16_f32 v250, v200, v201
    v_cvt_pk_bf16_f32 v251, v202, v203
    v_pk_mul_f32 v[172:173], v[172:173], s[78:79]
    v_pk_mul_f32 v[174:175], v[174:175], s[78:79]
    v_pk_mul_f32 v[204:205], v[204:205], s[78:79]
    v_pk_mul_f32 v[206:207], v[206:207], s[78:79]
    v_exp_f32 v172, v172
    v_exp_f32 v173, v173
    v_exp_f32 v174, v174
    v_exp_f32 v175, v175
    v_exp_f32 v204, v204
    v_exp_f32 v205, v205
    v_exp_f32 v206, v206
    v_exp_f32 v207, v207
    v_pk_add_f32 v[172:173], v[172:173], s[80:81]
    v_pk_add_f32 v[174:175], v[174:175], s[80:81]
    v_pk_add_f32 v[204:205], v[204:205], s[80:81]
    v_pk_add_f32 v[206:207], v[206:207], s[80:81]
    s_waitcnt lgkmcnt(0)
    v_mfma_f32_32x32x16_bf16 v[32:47], v[96:99], v[8:11], 0
    s_cmp_eq_u32 s33, 1
    s_cselect_b64 vcc, 0, -1
    s_mov_b32 s46, 0
    s_mov_b32 s67, 9584640
    s_cmp_eq_u32 s33, 1
    s_cselect_b32 s66, 9, 1
    v_rcp_f32 v172, v172
    v_rcp_f32 v173, v173
    v_rcp_f32 v174, v174
    v_rcp_f32 v175, v175
    v_rcp_f32 v204, v204
    v_rcp_f32 v205, v205
    v_rcp_f32 v206, v206
    v_rcp_f32 v207, v207
    v_pk_mul_f32 v[172:173], v[172:173], v[188:189]
    v_pk_mul_f32 v[174:175], v[174:175], v[190:191]
    v_pk_mul_f32 v[204:205], v[204:205], v[220:221]
    v_pk_mul_f32 v[206:207], v[206:207], v[222:223]
    v_cvt_pk_bf16_f32 v252, v172, v173
    v_cvt_pk_bf16_f32 v253, v174, v175
    v_cvt_pk_bf16_f32 v254, v204, v205
    v_cvt_pk_bf16_f32 v255, v206, v207
    s_branch L_st
L_qe:
    s_mov_b32 s12, s52
    s_and_b32 s13, s53, 0xffff
    s_mov_b32 s14, 1835008
    s_mov_b32 s15, 0x00020000
    s_mov_b32 s16, s44
    s_and_b32 s17, s45, 0xffff
    s_mov_b32 s18, 524288
    s_mov_b32 s19, 0x00020000
    s_mov_b32 s20, s56
    s_and_b32 s21, s57, 0xffff
    s_mov_b32 s22, 2097152
    s_mov_b32 s23, 0x00020000
    s_mov_b32 s68, s101
    s_lshl_b32 s99, s35, 1
    s_add_u32 s99, s99, s33
    s_mul_i32 s62, s32, 14
    s_mul_i32 s74, s99, 144
    s_add_u32 s74, s74, s62
    s_lshl_b32 s74, s74, 10
    s_xor_b32 s63, s99, 1
    s_mul_i32 s63, s63, 144
    s_add_u32 s63, s63, s62
    s_lshl_b32 s63, s63, 10
    s_add_u32 s4, s8, s74
    s_addc_u32 s5, s9, 0
    s_mov_b32 s6, 14336
    s_add_u32 s24, s8, s63
    s_addc_u32 s25, s9, 0
    s_mov_b32 s26, 14336
    s_mov_b32 s74, 0
    s_mul_i32 s75, s32, 229376
    s_sub_u32 s75, s75, 24576
    v_mov_b32 v56, 0
    v_mov_b32 v57, 0
    v_mov_b32 v58, 0
    v_mov_b32 v59, 0
    v_mov_b32 v60, 0
    v_mov_b32 v61, 0
    v_mov_b32 v62, 0
    v_mov_b32 v63, 0
    v_mfma_f32_32x32x16_bf16 v[64:79], v[56:59], v[56:59], 0
    v_mfma_f32_32x32x16_bf16 v[80:95], v[56:59], v[56:59], 0
    v_mov_b32 v104, v26
    v_mov_b32 v105, v26
    v_mov_b32 v106, v26
    v_mov_b32 v107, v26
    v_mov_b32 v108, v26
    v_mov_b32 v109, v26
    v_mov_b32 v110, v26
    v_mov_b32 v111, v26
    v_mov_b32 v112, v26
    v_mov_b32 v113, v26
    v_mov_b32 v114, v26
    v_mov_b32 v115, v26
    v_mov_b32 v116, v26
    v_mov_b32 v117, v26
    v_mov_b32 v118, v26
    v_mov_b32 v119, v26
    v_add_u32 v120, 15360, v24
    v_add_u32 v121, 7168, v24
L_p2:
    ds_read_b128 v[96:99], v20
    s_mov_b64 exec, s[72:73]
    ds_read_b128 v[104:107], v21
    ds_read_b128 v[108:111], v21 offset:512
    s_mov_b64 exec, -1
    s_cmp_eq_u32 s33, 1
    s_cselect_b64 vcc, 0, -1
    s_mov_b32 s46, 0
    s_mov_b32 s67, 9584640
    s_cmp_eq_u32 s33, 1
    s_cselect_b32 s66, 9, 1
    s_waitcnt lgkmcnt(2)
    v_mfma_f32_32x32x16_bf16 v[32:47], v[96:99], v[8:11], 0
    s_waitcnt lgkmcnt(0)
    s_nop 9
    s_branch L_a0
L_st:
    v_exp_f32 v32, v32
    v_exp_f32 v33, v33
    v_smfmac_f32_32x32x32_bf16 v[80:95], v[116:119], v[56:63], v19
    s_cbranch_vccz L_pr1468
    s_setprio 2
L_pr1468:
    s_mov_b64 exec, s[72:73]
    ds_read_b128 v[112:115], v21 offset:2048
    ds_read_b128 v[116:119], v21 offset:2560
    s_mov_b64 exec, -1
    v_exp_f32 v34, v34
    v_exp_f32 v35, v35
    v_exp_f32 v36, v36
    v_exp_f32 v37, v37
    v_mfma_f32_32x32x16_bf16 v[48:63], v[96:99], v[12:15], 0
    ds_read_b128 v[100:103], v20 offset:2048
    buffer_store_dwordx4 v[224:227], v3, s[8:11], s76 offen offset:0 sc1
    v_exp_f32 v38, v38
    v_exp_f32 v39, v39
    v_exp_f32 v40, v40
    v_exp_f32 v41, v41
    v_exp_f32 v42, v42
    v_smfmac_f32_32x32x32_bf16 v[64:79], v[104:107], v[32:39], v19
    v_exp_f32 v43, v43
    v_exp_f32 v44, v44
    v_exp_f32 v45, v45
    v_exp_f32 v46, v46
    v_exp_f32 v47, v47
    v_exp_f32 v48, v48
    v_exp_f32 v49, v49
    v_smfmac_f32_32x32x32_bf16 v[64:79], v[108:111], v[40:47], v19
    s_waitcnt lgkmcnt(0)
    v_exp_f32 v50, v50
    v_exp_f32 v51, v51
    v_exp_f32 v52, v52
    v_exp_f32 v53, v53
    v_mfma_f32_32x32x16_bf16 v[32:47], v[100:103], v[8:11], 0
    buffer_store_dwordx4 v[228:231], v3, s[8:11], s76 offen offset:256 sc1
    v_exp_f32 v54, v54
    v_exp_f32 v55, v55
    v_exp_f32 v56, v56
    v_exp_f32 v57, v57
    v_exp_f32 v58, v58
    v_smfmac_f32_32x32x32_bf16 v[80:95], v[104:107], v[48:55], v19
    v_exp_f32 v59, v59
    v_exp_f32 v60, v60
    v_exp_f32 v61, v61
    v_exp_f32 v62, v62
    v_exp_f32 v63, v63
    v_exp_f32 v32, v32
    v_exp_f32 v33, v33
    v_smfmac_f32_32x32x32_bf16 v[80:95], v[108:111], v[56:63], v19
    s_mov_b64 exec, s[72:73]
    ds_read_b128 v[104:107], v21 offset:4096
    ds_read_b128 v[108:111], v21 offset:4608
    s_mov_b64 exec, -1
    v_exp_f32 v34, v34
    v_exp_f32 v35, v35
    v_exp_f32 v36, v36
    v_exp_f32 v37, v37
    v_mfma_f32_32x32x16_bf16 v[48:63], v[100:103], v[12:15], 0
    ds_read_b128 v[96:99], v20 offset:4096
    buffer_store_dwordx4 v[232:235], v3, s[8:11], s77 offen offset:0 sc1
    v_exp_f32 v38, v38
    v_exp_f32 v39, v39
    v_exp_f32 v40, v40
    v_exp_f32 v41, v41
    v_exp_f32 v42, v42
    v_smfmac_f32_32x32x32_bf16 v[64:79], v[112:115], v[32:39], v19
    v_exp_f32 v43, v43
    v_exp_f32 v44, v44
    v_exp_f32 v45, v45
    v_exp_f32 v46, v46
    v_exp_f32 v47, v47
    v_exp_f32 v48, v48
    v_exp_f32 v49, v49
    v_smfmac_f32_32x32x32_bf16 v[64:79], v[116:119], v[40:47], v19
    s_waitcnt lgkmcnt(0)
    v_exp_f32 v50, v50
    v_exp_f32 v51, v51
    v_exp_f32 v52, v52
    v_exp_f32 v53, v53
    v_mfma_f32_32x32x16_bf16 v[32:47], v[96:99], v[8:11], 0
    buffer_store_dwordx4 v[236:239], v3, s[8:11], s77 offen offset:256 sc1
    v_exp_f32 v54, v54
    v_exp_f32 v55, v55
    v_exp_f32 v56, v56
    v_exp_f32 v57, v57
    v_exp_f32 v58, v58
    v_smfmac_f32_32x32x32_bf16 v[80:95], v[112:115], v[48:55], v19
    v_exp_f32 v59, v59
    v_exp_f32 v60, v60
    v_exp_f32 v61, v61
    v_exp_f32 v62, v62
    v_exp_f32 v63, v63
    v_exp_f32 v32, v32
    v_exp_f32 v33, v33
    v_smfmac_f32_32x32x32_bf16 v[80:95], v[116:119], v[56:63], v19
    s_mov_b64 exec, s[72:73]
    ds_read_b128 v[112:115], v21 offset:6144
    ds_read_b128 v[116:119], v21 offset:6656
    s_mov_b64 exec, -1
    v_exp_f32 v34, v34
    v_exp_f32 v35, v35
    v_exp_f32 v36, v36
    v_exp_f32 v37, v37
    v_mfma_f32_32x32x16_bf16 v[48:63], v[96:99], v[12:15], 0
    ds_read_b128 v[100:103], v20 offset:6144
    buffer_store_dwordx4 v[240:243], v3, s[8:11], s76 offen offset:2048 sc1
    v_exp_f32 v38, v38
    v_exp_f32 v39, v39
    v_exp_f32 v40, v40
    v_exp_f32 v41, v41
    v_exp_f32 v42, v42
    v_smfmac_f32_32x32x32_bf16 v[64:79], v[104:107], v[32:39], v19
    v_exp_f32 v43, v43
    v_exp_f32 v44, v44
    v_exp_f32 v45, v45
    v_exp_f32 v46, v46
    v_exp_f32 v47, v47
    v_exp_f32 v48, v48
    v_exp_f32 v49, v49
    v_smfmac_f32_32x32x32_bf16 v[64:79], v[108:111], v[40:47], v19
    s_waitcnt lgkmcnt(0)
    v_exp_f32 v50, v50
    v_exp_f32 v51, v51
    v_exp_f32 v52, v52
    v_exp_f32 v53, v53
    v_mfma_f32_32x32x16_bf16 v[32:47], v[100:103], v[8:11], 0
    buffer_store_dwordx4 v[244:247], v3, s[8:11], s76 offen offset:2304 sc1
    v_exp_f32 v54, v54
    v_exp_f32 v55, v55
    v_exp_f32 v56, v56
    v_exp_f32 v57, v57
    v_exp_f32 v58, v58
    v_smfmac_f32_32x32x32_bf16 v[80:95], v[104:107], v[48:55], v19
    v_exp_f32 v59, v59
    v_exp_f32 v60, v60
    v_exp_f32 v61, v61
    v_exp_f32 v62, v62
    v_exp_f32 v63, v63
    v_exp_f32 v32, v32
    v_exp_f32 v33, v33
    v_smfmac_f32_32x32x32_bf16 v[80:95], v[108:111], v[56:63], v19
    s_mov_b64 exec, s[72:73]
    ds_read_b128 v[104:107], v21 offset:8192
    ds_read_b128 v[108:111], v21 offset:8704
    s_mov_b64 exec, -1
    v_exp_f32 v34, v34
    v_exp_f32 v35, v35
    v_exp_f32 v36, v36
    v_exp_f32 v37, v37
    v_mfma_f32_32x32x16_bf16 v[48:63], v[100:103], v[12:15], 0
    ds_read_b128 v[96:99], v20 offset:8192
    buffer_store_dwordx4 v[248:251], v3, s[8:11], s77 offen offset:2048 sc1
    v_exp_f32 v38, v38
    v_exp_f32 v39, v39
    v_exp_f32 v40, v40
    v_exp_f32 v41, v41
    v_exp_f32 v42, v42
    v_smfmac_f32_32x32x32_bf16 v[64:79], v[112:115], v[32:39], v19
    s_cbranch_vccz L_pr1626
    s_setprio 0
L_pr1626:
    v_exp_f32 v43, v43
    v_exp_f32 v44, v44
    v_exp_f32 v45, v45
    v_exp_f32 v46, v46
    v_exp_f32 v47, v47
    v_exp_f32 v48, v48
    v_exp_f32 v49, v49
    v_smfmac_f32_32x32x32_bf16 v[64:79], v[116:119], v[40:47], v19
    s_waitcnt lgkmcnt(0)
    v_exp_f32 v50, v50
    v_exp_f32 v51, v51
    v_exp_f32 v52, v52
    v_exp_f32 v53, v53
    v_mfma_f32_32x32x16_bf16 v[32:47], v[96:99], v[8:11], 0
    buffer_store_dwordx4 v[252:255], v3, s[8:11], s77 offen offset:2304 sc1
    v_exp_f32 v54, v54
    v_exp_f32 v55, v55
    v_exp_f32 v56, v56
    v_exp_f32 v57, v57
    v_exp_f32 v58, v58
    v_smfmac_f32_32x32x32_bf16 v[80:95], v[112:115], v[48:55], v19
    s_add_u32 s46, s46, 1
    v_add_u32 v20, 8192, v20
    v_add_u32 v21, 8192, v21
    v_exp_f32 v59, v59
    v_exp_f32 v60, v60
    v_exp_f32 v61, v61
    v_exp_f32 v62, v62
    v_exp_f32 v63, v63
L_a0:
    v_exp_f32 v32, v32
    v_exp_f32 v33, v33
    v_smfmac_f32_32x32x32_bf16 v[80:95], v[116:119], v[56:63], v19
    s_cbranch_vccz L_pr1662
    s_setprio 2
L_pr1662:
    s_mov_b64 exec, s[72:73]
    ds_read_b128 v[112:115], v21 offset:2048
    ds_read_b128 v[116:119], v21 offset:2560
    s_mov_b64 exec, -1
    v_exp_f32 v34, v34
    v_exp_f32 v35, v35
    v_exp_f32 v36, v36
    v_exp_f32 v37, v37
    v_mfma_f32_32x32x16_bf16 v[48:63], v[96:99], v[12:15], 0
    ds_read_b128 v[100:103], v20 offset:2048
    v_exp_f32 v38, v38
    v_exp_f32 v39, v39
    v_exp_f32 v40, v40
    v_exp_f32 v41, v41
    v_exp_f32 v42, v42
    v_smfmac_f32_32x32x32_bf16 v[64:79], v[104:107], v[32:39], v19
    s_nop 0
    v_exp_f32 v43, v43
    v_exp_f32 v44, v44
    v_exp_f32 v45, v45
    v_exp_f32 v46, v46
    v_exp_f32 v47, v47
    v_exp_f32 v48, v48
    v_exp_f32 v49, v49
    v_smfmac_f32_32x32x32_bf16 v[64:79], v[108:111], v[40:47], v19
    s_waitcnt lgkmcnt(0)
    v_exp_f32 v50, v50
    v_exp_f32 v51, v51
    v_exp_f32 v52, v52
    v_exp_f32 v53, v53
    v_mfma_f32_32x32x16_bf16 v[32:47], v[100:103], v[8:11], 0
    v_exp_f32 v54, v54
    v_exp_f32 v55, v55
    v_exp_f32 v56, v56
    v_exp_f32 v57, v57
    v_exp_f32 v58, v58
    v_smfmac_f32_32x32x32_bf16 v[80:95], v[104:107], v[48:55], v19
    s_cmp_eq_u32 s46, 3
    s_cbranch_scc1 L_hb0
L_hbr0:
    v_exp_f32 v59, v59
    v_exp_f32 v60, v60
    v_exp_f32 v61, v61
    v_exp_f32 v62, v62
    v_exp_f32 v63, v63
    v_exp_f32 v32, v32
    v_exp_f32 v33, v33
    v_smfmac_f32_32x32x32_bf16 v[80:95], v[108:111], v[56:63], v19
    s_mov_b64 exec, s[72:73]
    ds_read_b128 v[104:107], v21 offset:4096
    ds_read_b128 v[108:111], v21 offset:4608
    s_mov_b64 exec, -1
    v_exp_f32 v34, v34
    v_exp_f32 v35, v35
    v_exp_f32 v36, v36
    v_exp_f32 v37, v37
    v_mfma_f32_32x32x16_bf16 v[48:63], v[100:103], v[12:15], 0
    ds_read_b128 v[96:99], v20 offset:4096
    v_exp_f32 v38, v38
    v_exp_f32 v39, v39
    v_exp_f32 v40, v40
    v_exp_f32 v41, v41
    v_exp_f32 v42, v42
    v_smfmac_f32_32x32x32_bf16 v[64:79], v[112:115], v[32:39], v19
    s_cmp_eq_u32 s46, 3
    s_cbranch_scc1 L_hb1
L_hbr1:
    v_exp_f32 v43, v43
    v_exp_f32 v44, v44
    v_exp_f32 v45, v45
    v_exp_f32 v46, v46
    v_exp_f32 v47, v47
    v_exp_f32 v48, v48
    v_exp_f32 v49, v49
    v_smfmac_f32_32x32x32_bf16 v[64:79], v[116:119], v[40:47], v19
    s_waitcnt lgkmcnt(0)
    v_exp_f32 v50, v50
    v_exp_f32 v51, v51
    v_exp_f32 v52, v52
    v_exp_f32 v53, v53
    v_mfma_f32_32x32x16_bf16 v[32:47], v[96:99], v[8:11], 0
    v_exp_f32 v54, v54
    v_exp_f32 v55, v55
    v_exp_f32 v56, v56
    v_exp_f32 v57, v57
    v_exp_f32 v58, v58
    v_smfmac_f32_32x32x32_bf16 v[80:95], v[112:115], v[48:55], v19
    s_cmp_eq_u32 s46, 3
    s_cbranch_scc1 L_hb2
L_hbr2:
    v_exp_f32 v59, v59
    v_exp_f32 v60, v60
    v_exp_f32 v61, v61
    v_exp_f32 v62, v62
    v_exp_f32 v63, v63
    v_exp_f32 v32, v32
    v_exp_f32 v33, v33
    v_smfmac_f32_32x32x32_bf16 v[80:95], v[116:119], v[56:63], v19
    s_mov_b64 exec, s[72:73]
    ds_read_b128 v[112:115], v21 offset:6144
    ds_read_b128 v[116:119], v21 offset:6656
    s_mov_b64 exec, -1
    v_exp_f32 v34, v34
    v_exp_f32 v35, v35
    v_exp_f32 v36, v36
    v_exp_f32 v37, v37
    v_mfma_f32_32x32x16_bf16 v[48:63], v[96:99], v[12:15], 0
    ds_read_b128 v[100:103], v20 offset:6144
    v_exp_f32 v38, v38
    v_exp_f32 v39, v39
    v_exp_f32 v40, v40
    v_exp_f32 v41, v41
    v_exp_f32 v42, v42
    v_smfmac_f32_32x32x32_bf16 v[64:79], v[104:107], v[32:39], v19
    s_cmp_eq_u32 s46, 3
    s_cbranch_scc1 L_hb3
L_hbr3:
    v_exp_f32 v43, v43
    v_exp_f32 v44, v44
    v_exp_f32 v45, v45
    v_exp_f32 v46, v46
    v_exp_f32 v47, v47
    v_exp_f32 v48, v48
    v_exp_f32 v49, v49
    v_smfmac_f32_32x32x32_bf16 v[64:79], v[108:111], v[40:47], v19
    s_waitcnt lgkmcnt(0)
    v_exp_f32 v50, v50
    v_exp_f32 v51, v51
    v_exp_f32 v52, v52
    v_exp_f32 v53, v53
    v_mfma_f32_32x32x16_bf16 v[32:47], v[100:103], v[8:11], 0
    v_exp_f32 v54, v54
    v_exp_f32 v55, v55
    v_exp_f32 v56, v56
    v_exp_f32 v57, v57
    v_exp_f32 v58, v58
    v_smfmac_f32_32x32x32_bf16 v[80:95], v[104:107], v[48:55], v19
    s_cmp_eq_u32 s46, 3
    s_cbranch_scc1 L_hb4
L_hbr4:
    v_exp_f32 v59, v59
    v_exp_f32 v60, v60
    v_exp_f32 v61, v61
    v_exp_f32 v62, v62
    v_exp_f32 v63, v63
    v_exp_f32 v32, v32
    v_exp_f32 v33, v33
    v_smfmac_f32_32x32x32_bf16 v[80:95], v[108:111], v[56:63], v19
    s_mov_b64 exec, s[72:73]
    ds_read_b128 v[104:107], v21 offset:8192
    ds_read_b128 v[108:111], v21 offset:8704
    s_mov_b64 exec, -1
    v_exp_f32 v34, v34
    v_exp_f32 v35, v35
    v_exp_f32 v36, v36
    v_exp_f32 v37, v37
    v_mfma_f32_32x32x16_bf16 v[48:63], v[100:103], v[12:15], 0
    ds_read_b128 v[96:99], v20 offset:8192
    v_exp_f32 v38, v38
    v_exp_f32 v39, v39
    v_exp_f32 v40, v40
    v_exp_f32 v41, v41
    v_exp_f32 v42, v42
    v_smfmac_f32_32x32x32_bf16 v[64:79], v[112:115], v[32:39], v19
    s_cbranch_vccz L_pr1829
    s_setprio 0
L_pr1829:
    s_cmp_eq_u32 s46, s66
    s_cbranch_scc1 L_hf
L_hfr:
    v_exp_f32 v43, v43
    v_exp_f32 v44, v44
    v_exp_f32 v45, v45
    v_exp_f32 v46, v46
    v_exp_f32 v47, v47
    v_exp_f32 v48, v48
    v_exp_f32 v49, v49
    v_smfmac_f32_32x32x32_bf16 v[64:79], v[116:119], v[40:47], v19
    s_waitcnt lgkmcnt(0)
    v_exp_f32 v50, v50
    v_exp_f32 v51, v51
    v_exp_f32 v52, v52
    v_exp_f32 v53, v53
    v_mfma_f32_32x32x16_bf16 v[32:47], v[96:99], v[8:11], 0
    v_exp_f32 v54, v54
    v_exp_f32 v55, v55
    v_exp_f32 v56, v56
    v_exp_f32 v57, v57
    v_exp_f32 v58, v58
    v_smfmac_f32_32x32x32_bf16 v[80:95], v[112:115], v[48:55], v19
    s_cmp_lg_u32 s46, 2
    s_cbranch_scc1 L_hnp
    buffer_load_dwordx4 v[240:243], v17, s[8:11], s67 offen sc1
L_hnp:
    s_add_u32 s46, s46, 1
    v_add_u32 v20, 8192, v20
    v_add_u32 v21, 8192, v21
    s_cmp_lt_u32 s46, 4
    v_exp_f32 v59, v59
    v_exp_f32 v60, v60
    v_exp_f32 v61, v61
    v_exp_f32 v62, v62
    v_exp_f32 v63, v63
    s_cbranch_scc1 L_a0
    s_branch L_gb
L_hf:
    s_lshl_b32 s62, s28, 4
    s_add_u32 s62, s62, s29
    s_lshl_b32 s62, s62, 5
    s_add_u32 s62, s62, s34
    s_lshl_b32 s62, s62, 2
    s_add_u32 s62, s62, s67
    v_mov_b32 v5, 1
    v_mov_b32 v16, 0
    s_waitcnt vmcnt(0)
    s_mov_b64 exec, 1
    buffer_store_dword v5, v16, s[8:11], s62 offen sc1
    s_mov_b64 exec, -1
    s_and_b32 s62, s31, 7
    s_lshl_b32 s62, s62, 2
    s_add_u32 s62, s62, s34
    s_lshl_b32 s62, s62, 16
    s_lshl_b32 s63, s71, 7
    s_add_u32 s62, s62, s63
    v_lshlrev_b32 v16, 10, v0
    s_add_u32 s63, s62, 0
    buffer_load_dword v31, v16, s[12:15], s63 offen
    s_add_u32 s63, s62, 4293132288
    buffer_load_dword v31, v16, s[16:19], s63 offen
    s_add_u32 s63, s62, 262144
    buffer_load_dword v31, v16, s[16:19], s63 offen
    s_branch L_hfr
L_hb0:
    s_waitcnt vmcnt(0)
    s_mov_b32 s70, 1048576
L_hp:
    v_min3_u32 v241, v241, v242, v243
    v_min_u32 v240, v240, v241
    v_cmp_ne_u32 vcc, 0, v240
    s_cmp_eq_u64 vcc, -1
    s_cbranch_scc1 L_hp_ok
    s_sub_u32 s70, s70, 1
    s_cbranch_scc1 L_hp_ok
    s_sleep 16
    buffer_load_dwordx4 v[240:243], v17, s[8:11], s67 offen sc1
    s_waitcnt vmcnt(0)
    s_branch L_hp
L_hp_ok:
    v_and_b32 v16, 0x7c, v18
    s_lshl_b32 s62, s28, 9
    s_lshl_b32 s63, s34, 7
    s_add_u32 s62, s62, s63
    s_add_u32 s62, s62, 9568256
    buffer_load_dword v26, v16, s[8:11], s62 offen sc1
    s_lshl_b32 s62, s99, 7
    s_add_u32 s62, s62, 9568256
    buffer_load_dword v27, v16, s[8:11], s62 offen sc1
    v_mov_b32 v236, 0
    v_mov_b32 v237, 0
    v_mov_b32 v238, 0
    v_mov_b32 v239, 0
    s_cmp_eq_u32 s33, 1
    s_cselect_b64 vcc, 0, -1
    s_mov_b32 s70, 2
    v_mfma_f32_32x32x16_bf16 v[208:223], v[236:239], v[236:239], 0
    s_branch L_hbr0
L_hb1:
    buffer_load_dwordx4 v[192:195], v2, s[4:7], s74 offen offset:0 sc1
    buffer_load_dwordx4 v[196:199], v2, s[24:27], s74 offen offset:0 sc1
    buffer_load_dwordx4 v[200:203], v2, s[4:7], s74 offen offset:1024 sc1
    v_mfma_f32_32x32x16_bf16 v[128:143], v[236:239], v[236:239], 0
    s_branch L_hbr1
L_hb2:
    buffer_load_dwordx4 v[204:207], v2, s[24:27], s74 offen offset:1024 sc1
    s_add_u32 m0, s101, 0
    s_add_u32 s75, s75, 24576
    buffer_load_dwordx4 v24, s[12:15], s75 offen lds
    buffer_load_dwordx4 v120, s[12:15], s75 offen offset:1024 lds
    v_mfma_f32_32x32x16_bf16 v[144:159], v[236:239], v[236:239], 0
    s_branch L_hbr2
L_hb3:
    buffer_load_dwordx4 v[224:227], v2, s[4:7], s74 offen offset:2048 sc1
    buffer_load_dwordx4 v[228:231], v2, s[24:27], s74 offen offset:2048 sc1
    s_mov_b32 s3, 4096
    s_mul_i32 s64, s33, 98304
    s_lshl_b32 s65, s34, 13
    s_add_u32 s64, s64, s65
    s_lshl_b32 s65, s32, 16
    v_mfma_f32_32x32x16_bf16 v[160:175], v[236:239], v[236:239], 0
    s_branch L_hbr3
L_hb4:
    s_add_u32 m0, s101, 2048
    s_add_u32 s75, s75, 8192
    buffer_load_dwordx4 v24, s[12:15], s75 offen lds
    buffer_load_dwordx4 v120, s[12:15], s75 offen offset:1024 lds
    buffer_load_dwordx4 v[232:235], v2, s[4:7], s74 offen offset:3072 sc1
    v_mfma_f32_32x32x16_bf16 v[176:191], v[236:239], v[236:239], 0
    s_branch L_hbr4
L_gb:
    s_barrier
    s_mov_b32 m0, s64
    s_add_u32 s64, s64, 2048
    buffer_load_dwordx4 v24, s[16:19], s65 offen lds
    buffer_load_dwordx4 v121, s[16:19], s65 offen offset:1024 lds
    s_add_u32 s65, s65, 16384
L_g:
    v_exp_f32 v32, v32
    v_exp_f32 v33, v33
    v_smfmac_f32_32x32x32_bf16 v[80:95], v[116:119], v[56:63], v19
    s_cbranch_vccz L_pr1974
    s_setprio 2
L_pr1974:
    s_mov_b64 exec, s[72:73]
    ds_read_b128 v[112:115], v21 offset:2048
    ds_read_b128 v[116:119], v21 offset:2560
    s_mov_b64 exec, -1
    v_exp_f32 v34, v34
    v_exp_f32 v35, v35
    v_exp_f32 v36, v36
    v_mfma_f32_32x32x16_bf16 v[48:63], v[96:99], v[12:15], 0
    s_waitcnt vmcnt(5)
    ds_read_b128 v[100:103], v20 offset:2048
    ds_read_b64_tr_b16 v[208:209], v22 offset:0
    ds_read_b64_tr_b16 v[210:211], v22 offset:1024
    v_exp_f32 v37, v37
    v_exp_f32 v38, v38
    v_exp_f32 v39, v39
    v_mfma_f32_32x32x16_bf16 v[160:175], v[216:219], v[236:239], v[160:175]
    ds_read_b64_tr_b16 v[212:213], v23 offset:0
    ds_read_b64_tr_b16 v[214:215], v23 offset:1024
    v_exp_f32 v40, v40
    v_exp_f32 v41, v41
    v_exp_f32 v42, v42
    v_smfmac_f32_32x32x32_bf16 v[64:79], v[104:107], v[32:39], v19
    s_mov_b32 m0, s64
    s_add_u32 s64, s64, 2048
    buffer_load_dwordx4 v24, s[16:19], s65 offen lds
    buffer_load_dwordx4 v121, s[16:19], s65 offen offset:1024 lds
    s_add_u32 s65, s65, 16384
    v_exp_f32 v43, v43
    v_exp_f32 v44, v44
    v_exp_f32 v45, v45
    v_mfma_f32_32x32x16_bf16 v[176:191], v[220:223], v[236:239], v[176:191]
    buffer_load_dwordx4 v[236:239], v2, s[24:27], s74 offen offset:3072 sc1
    v_exp_f32 v46, v46
    v_exp_f32 v47, v47
    v_exp_f32 v48, v48
    v_exp_f32 v49, v49
    v_smfmac_f32_32x32x32_bf16 v[64:79], v[108:111], v[40:47], v19
    s_waitcnt lgkmcnt(0)
    s_add_u32 m0, s101, 0
    s_add_u32 s75, s75, 24576
    buffer_load_dwordx4 v24, s[12:15], s75 offen lds
    buffer_load_dwordx4 v120, s[12:15], s75 offen offset:1024 lds
    v_exp_f32 v50, v50
    v_exp_f32 v51, v51
    v_exp_f32 v52, v52
    v_mfma_f32_32x32x16_bf16 v[32:47], v[100:103], v[8:11], 0
    v_exp_f32 v53, v53
    v_exp_f32 v54, v54
    v_exp_f32 v55, v55
    v_mfma_f32_32x32x16_bf16 v[128:143], v[208:211], v[192:195], v[128:143]
    v_exp_f32 v56, v56
    v_exp_f32 v57, v57
    v_exp_f32 v58, v58
    v_smfmac_f32_32x32x32_bf16 v[80:95], v[104:107], v[48:55], v19
    v_exp_f32 v59, v59
    v_exp_f32 v60, v60
    v_exp_f32 v61, v61
    v_mfma_f32_32x32x16_bf16 v[144:159], v[212:215], v[192:195], v[144:159]
    buffer_load_dwordx4 v[192:195], v2, s[4:7], s3 offen offset:0 sc1
    v_exp_f32 v62, v62
    v_exp_f32 v63, v63
    v_exp_f32 v32, v32
    v_exp_f32 v33, v33
    v_smfmac_f32_32x32x32_bf16 v[80:95], v[108:111], v[56:63], v19
    s_mov_b64 exec, s[72:73]
    ds_read_b128 v[104:107], v21 offset:4096
    ds_read_b128 v[108:111], v21 offset:4608
    s_mov_b64 exec, -1
    v_exp_f32 v34, v34
    v_exp_f32 v35, v35
    v_exp_f32 v36, v36
    v_mfma_f32_32x32x16_bf16 v[48:63], v[100:103], v[12:15], 0
    s_waitcnt vmcnt(7)
    ds_read_b128 v[96:99], v20 offset:4096
    ds_read_b64_tr_b16 v[216:217], v22 offset:2048
    ds_read_b64_tr_b16 v[218:219], v22 offset:3072
    v_exp_f32 v37, v37
    v_exp_f32 v38, v38
    v_exp_f32 v39, v39
    v_mfma_f32_32x32x16_bf16 v[160:175], v[208:211], v[196:199], v[160:175]
    ds_read_b64_tr_b16 v[220:221], v23 offset:2048
    ds_read_b64_tr_b16 v[222:223], v23 offset:3072
    v_exp_f32 v40, v40
    v_exp_f32 v41, v41
    v_exp_f32 v42, v42
    v_smfmac_f32_32x32x32_bf16 v[64:79], v[112:115], v[32:39], v19
    v_exp_f32 v43, v43
    v_exp_f32 v44, v44
    v_exp_f32 v45, v45
    v_mfma_f32_32x32x16_bf16 v[176:191], v[212:215], v[196:199], v[176:191]
    buffer_load_dwordx4 v[196:199], v2, s[24:27], s3 offen offset:0 sc1
    v_exp_f32 v46, v46
    v_exp_f32 v47, v47
    v_exp_f32 v48, v48
    v_exp_f32 v49, v49
    v_smfmac_f32_32x32x32_bf16 v[64:79], v[116:119], v[40:47], v19
    s_waitcnt lgkmcnt(0)
    s_add_u32 m0, s101, 2048
    s_add_u32 s75, s75, 8192
    buffer_load_dwordx4 v24, s[12:15], s75 offen lds
    buffer_load_dwordx4 v120, s[12:15], s75 offen offset:1024 lds
    v_exp_f32 v50, v50
    v_exp_f32 v51, v51
    v_exp_f32 v52, v52
    v_mfma_f32_32x32x16_bf16 v[32:47], v[96:99], v[8:11], 0
    v_exp_f32 v53, v53
    v_exp_f32 v54, v54
    v_exp_f32 v55, v55
    v_mfma_f32_32x32x16_bf16 v[128:143], v[216:219], v[200:203], v[128:143]
    v_exp_f32 v56, v56
    v_exp_f32 v57, v57
    v_exp_f32 v58, v58
    v_smfmac_f32_32x32x32_bf16 v[80:95], v[112:115], v[48:55], v19
    v_exp_f32 v59, v59
    v_exp_f32 v60, v60
    v_exp_f32 v61, v61
    v_mfma_f32_32x32x16_bf16 v[144:159], v[220:223], v[200:203], v[144:159]
    buffer_load_dwordx4 v[200:203], v2, s[4:7], s3 offen offset:1024 sc1
    v_exp_f32 v62, v62
    v_exp_f32 v63, v63
    v_exp_f32 v32, v32
    v_exp_f32 v33, v33
    v_smfmac_f32_32x32x32_bf16 v[80:95], v[116:119], v[56:63], v19
    s_mov_b64 exec, s[72:73]
    ds_read_b128 v[112:115], v21 offset:6144
    ds_read_b128 v[116:119], v21 offset:6656
    s_mov_b64 exec, -1
    v_exp_f32 v34, v34
    v_exp_f32 v35, v35
    v_exp_f32 v36, v36
    v_mfma_f32_32x32x16_bf16 v[48:63], v[96:99], v[12:15], 0
    s_waitcnt vmcnt(5)
    ds_read_b128 v[100:103], v20 offset:6144
    ds_read_b64_tr_b16 v[208:209], v22 offset:0
    ds_read_b64_tr_b16 v[210:211], v22 offset:1024
    v_exp_f32 v37, v37
    v_exp_f32 v38, v38
    v_exp_f32 v39, v39
    v_mfma_f32_32x32x16_bf16 v[160:175], v[216:219], v[204:207], v[160:175]
    ds_read_b64_tr_b16 v[212:213], v23 offset:0
    ds_read_b64_tr_b16 v[214:215], v23 offset:1024
    v_exp_f32 v40, v40
    v_exp_f32 v41, v41
    v_exp_f32 v42, v42
    v_smfmac_f32_32x32x32_bf16 v[64:79], v[104:107], v[32:39], v19
    v_exp_f32 v43, v43
    v_exp_f32 v44, v44
    v_exp_f32 v45, v45
    v_mfma_f32_32x32x16_bf16 v[176:191], v[220:223], v[204:207], v[176:191]
    buffer_load_dwordx4 v[204:207], v2, s[24:27], s3 offen offset:1024 sc1
    v_exp_f32 v46, v46
    v_exp_f32 v47, v47
    v_exp_f32 v48, v48
    v_exp_f32 v49, v49
    v_smfmac_f32_32x32x32_bf16 v[64:79], v[108:111], v[40:47], v19
    s_waitcnt lgkmcnt(0)
    s_add_u32 m0, s101, 0
    s_add_u32 s75, s75, 24576
    buffer_load_dwordx4 v24, s[12:15], s75 offen lds
    buffer_load_dwordx4 v120, s[12:15], s75 offen offset:1024 lds
    v_exp_f32 v50, v50
    v_exp_f32 v51, v51
    v_exp_f32 v52, v52
    v_mfma_f32_32x32x16_bf16 v[32:47], v[100:103], v[8:11], 0
    v_exp_f32 v53, v53
    v_exp_f32 v54, v54
    v_exp_f32 v55, v55
    v_mfma_f32_32x32x16_bf16 v[128:143], v[208:211], v[224:227], v[128:143]
    v_exp_f32 v56, v56
    v_exp_f32 v57, v57
    v_exp_f32 v58, v58
    v_smfmac_f32_32x32x32_bf16 v[80:95], v[104:107], v[48:55], v19
    s_cbranch_vccz L_pr2149
    s_setprio 0
L_pr2149:
    v_exp_f32 v59, v59
    v_exp_f32 v60, v60
    v_exp_f32 v61, v61
    v_mfma_f32_32x32x16_bf16 v[144:159], v[212:215], v[224:227], v[144:159]
    buffer_load_dwordx4 v[224:227], v2, s[4:7], s3 offen offset:2048 sc1
    v_exp_f32 v62, v62
    v_exp_f32 v63, v63
    v_exp_f32 v32, v32
    v_exp_f32 v33, v33
    v_smfmac_f32_32x32x32_bf16 v[80:95], v[108:111], v[56:63], v19
    s_mov_b64 exec, s[72:73]
    ds_read_b128 v[104:107], v21 offset:8192
    ds_read_b128 v[108:111], v21 offset:8704
    s_mov_b64 exec, -1
    v_exp_f32 v34, v34
    v_exp_f32 v35, v35
    v_exp_f32 v36, v36
    v_mfma_f32_32x32x16_bf16 v[48:63], v[100:103], v[12:15], 0
    s_waitcnt vmcnt(5)
    ds_read_b128 v[96:99], v20 offset:8192
    ds_read_b64_tr_b16 v[216:217], v22 offset:2048
    ds_read_b64_tr_b16 v[218:219], v22 offset:3072
    v_exp_f32 v37, v37
    v_exp_f32 v38, v38
    v_exp_f32 v39, v39
    v_mfma_f32_32x32x16_bf16 v[160:175], v[208:211], v[228:231], v[160:175]
    ds_read_b64_tr_b16 v[220:221], v23 offset:2048
    ds_read_b64_tr_b16 v[222:223], v23 offset:3072
    v_exp_f32 v40, v40
    v_exp_f32 v41, v41
    v_exp_f32 v42, v42
    v_smfmac_f32_32x32x32_bf16 v[64:79], v[112:115], v[32:39], v19
    v_exp_f32 v43, v43
    v_exp_f32 v44, v44
    v_exp_f32 v45, v45
    v_mfma_f32_32x32x16_bf16 v[176:191], v[212:215], v[228:231], v[176:191]
    buffer_load_dwordx4 v[228:231], v2, s[24:27], s3 offen offset:2048 sc1
    v_exp_f32 v46, v46
    v_exp_f32 v47, v47
    v_exp_f32 v48, v48
    v_exp_f32 v49, v49
    v_smfmac_f32_32x32x32_bf16 v[64:79], v[116:119], v[40:47], v19
    s_waitcnt lgkmcnt(0)
    s_add_u32 m0, s101, 2048
    s_add_u32 s75, s75, 8192
    buffer_load_dwordx4 v24, s[12:15], s75 offen lds
    buffer_load_dwordx4 v120, s[12:15], s75 offen offset:1024 lds
    v_exp_f32 v50, v50
    v_exp_f32 v51, v51
    v_exp_f32 v52, v52
    v_mfma_f32_32x32x16_bf16 v[32:47], v[96:99], v[8:11], 0
    v_exp_f32 v53, v53
    v_exp_f32 v54, v54
    v_exp_f32 v55, v55
    v_mfma_f32_32x32x16_bf16 v[128:143], v[216:219], v[232:235], v[128:143]
    v_exp_f32 v56, v56
    v_exp_f32 v57, v57
    v_exp_f32 v58, v58
    v_smfmac_f32_32x32x32_bf16 v[80:95], v[112:115], v[48:55], v19
    v_exp_f32 v59, v59
    v_exp_f32 v60, v60
    v_exp_f32 v61, v61
    v_mfma_f32_32x32x16_bf16 v[144:159], v[220:223], v[232:235], v[144:159]
    buffer_load_dwordx4 v[232:235], v2, s[4:7], s3 offen offset:3072 sc1
    s_add_u32 s74, s74, 4096
    s_add_u32 s3, s3, 4096
    s_sub_u32 s70, s70, 1
    v_add_u32 v20, 8192, v20
    v_add_u32 v21, 8192, v21
    v_exp_f32 v62, v62
    v_exp_f32 v63, v63
    s_cbranch_scc0 L_g
    s_lshr_b32 s62, s34, 1
    s_mul_i32 s62, s62, 98304
    s_and_b32 s63, s34, 1
    s_lshl_b32 s63, s63, 14
    s_add_u32 s74, s62, s63
    v_add_u32 v124, s74, v25
    v_xor_b32 v125, 64, v124
    s_mul_i32 s62, s33, 98304
    s_mul_i32 s63, s34, 6144
    s_add_u32 s63, s63, 32768
    s_lshl_b32 s64, s34, 9
    s_add_u32 s64, s64, 57344
    s_add_u32 s65, s62, s63
    v_add_u32 v126, s65, v2
    s_add_u32 s65, s62, s64
    v_add_u32 v17, s65, v18
    v_add_u32 v16, s68, v2
    s_xor_b32 s62, s62, 98304
    s_add_u32 s75, s62, s63
    s_add_u32 s46, s62, s64
    s_lshl_b32 s64, s28, 2
    s_add_u32 s64, s64, s34
    s_mul_i32 s65, s64, 144
    s_lshl_b32 s63, s29, 1
    s_add_u32 s63, s63, s33
    s_add_u32 s65, s65, s63
    s_add_u32 s65, s65, 112
    s_lshl_b32 s65, s65, 10
    s_barrier
    v_exp_f32 v32, v32
    v_exp_f32 v33, v33
    v_smfmac_f32_32x32x32_bf16 v[80:95], v[116:119], v[56:63], v19
    s_cbranch_vccz L_pr2256
    s_setprio 2
L_pr2256:
    s_mov_b64 exec, s[72:73]
    ds_read_b128 v[112:115], v21 offset:2048
    ds_read_b128 v[116:119], v21 offset:2560
    s_mov_b64 exec, -1
    v_exp_f32 v34, v34
    v_exp_f32 v35, v35
    v_exp_f32 v36, v36
    v_mfma_f32_32x32x16_bf16 v[48:63], v[96:99], v[12:15], 0
    s_waitcnt vmcnt(5)
    ds_read_b128 v[100:103], v20 offset:2048
    ds_read_b64_tr_b16 v[208:209], v22 offset:0
    ds_read_b64_tr_b16 v[210:211], v22 offset:1024
    v_exp_f32 v37, v37
    v_exp_f32 v38, v38
    v_exp_f32 v39, v39
    v_mfma_f32_32x32x16_bf16 v[160:175], v[216:219], v[236:239], v[160:175]
    ds_read_b64_tr_b16 v[212:213], v23 offset:0
    ds_read_b64_tr_b16 v[214:215], v23 offset:1024
    v_exp_f32 v40, v40
    v_exp_f32 v41, v41
    v_exp_f32 v42, v42
    v_smfmac_f32_32x32x32_bf16 v[64:79], v[104:107], v[32:39], v19
    v_exp_f32 v43, v43
    v_exp_f32 v44, v44
    v_exp_f32 v45, v45
    v_mfma_f32_32x32x16_bf16 v[176:191], v[220:223], v[236:239], v[176:191]
    v_exp_f32 v46, v46
    v_exp_f32 v47, v47
    v_exp_f32 v48, v48
    v_exp_f32 v49, v49
    v_smfmac_f32_32x32x32_bf16 v[64:79], v[108:111], v[40:47], v19
    s_waitcnt lgkmcnt(0)
    v_exp_f32 v50, v50
    v_exp_f32 v51, v51
    v_exp_f32 v52, v52
    v_mfma_f32_32x32x16_bf16 v[32:47], v[100:103], v[8:11], 0
    ds_read_b64_tr_b16 v[240:241], v124 offset:0
    ds_read_b64_tr_b16 v[242:243], v124 offset:1024
    v_exp_f32 v53, v53
    v_exp_f32 v54, v54
    v_exp_f32 v55, v55
    v_mfma_f32_32x32x16_bf16 v[128:143], v[208:211], v[192:195], v[128:143]
    ds_read_b64_tr_b16 v[244:245], v125 offset:0
    ds_read_b64_tr_b16 v[246:247], v125 offset:1024
    v_exp_f32 v56, v56
    v_exp_f32 v57, v57
    v_exp_f32 v58, v58
    v_smfmac_f32_32x32x32_bf16 v[80:95], v[104:107], v[48:55], v19
    ds_read_b64_tr_b16 v[248:249], v124 offset:2048
    ds_read_b64_tr_b16 v[250:251], v124 offset:3072
    v_exp_f32 v59, v59
    v_exp_f32 v60, v60
    v_exp_f32 v61, v61
    v_mfma_f32_32x32x16_bf16 v[144:159], v[212:215], v[192:195], v[144:159]
    ds_read_b64_tr_b16 v[252:253], v125 offset:2048
    ds_read_b64_tr_b16 v[254:255], v125 offset:3072
    v_exp_f32 v62, v62
    v_exp_f32 v63, v63
    v_exp_f32 v32, v32
    v_exp_f32 v33, v33
    v_smfmac_f32_32x32x32_bf16 v[80:95], v[108:111], v[56:63], v19
    s_mov_b64 exec, s[72:73]
    ds_read_b128 v[104:107], v21 offset:4096
    ds_read_b128 v[108:111], v21 offset:4608
    s_mov_b64 exec, -1
    v_exp_f32 v34, v34
    v_exp_f32 v35, v35
    v_exp_f32 v36, v36
    v_mfma_f32_32x32x16_bf16 v[48:63], v[100:103], v[12:15], 0
    s_waitcnt vmcnt(0)
    ds_read_b128 v[96:99], v20 offset:4096
    ds_read_b64_tr_b16 v[216:217], v22 offset:2048
    ds_read_b64_tr_b16 v[218:219], v22 offset:3072
    v_exp_f32 v37, v37
    v_exp_f32 v38, v38
    v_exp_f32 v39, v39
    v_mfma_f32_32x32x16_bf16 v[160:175], v[208:211], v[196:199], v[160:175]
    ds_read_b64_tr_b16 v[220:221], v23 offset:2048
    ds_read_b64_tr_b16 v[222:223], v23 offset:3072
    v_exp_f32 v40, v40
    v_exp_f32 v41, v41
    v_exp_f32 v42, v42
    v_smfmac_f32_32x32x32_bf16 v[64:79], v[112:115], v[32:39], v19
    v_exp_f32 v43, v43
    v_exp_f32 v44, v44
    v_exp_f32 v45, v45
    v_mfma_f32_32x32x16_bf16 v[176:191], v[212:215], v[196:199], v[176:191]
    v_exp_f32 v46, v46
    v_exp_f32 v47, v47
    v_exp_f32 v48, v48
    v_exp_f32 v49, v49
    v_smfmac_f32_32x32x32_bf16 v[64:79], v[116:119], v[40:47], v19
    s_waitcnt lgkmcnt(0)
    v_exp_f32 v50, v50
    v_exp_f32 v51, v51
    v_exp_f32 v52, v52
    v_mfma_f32_32x32x16_bf16 v[32:47], v[96:99], v[8:11], 0
    ds_read_b64_tr_b16 v[224:225], v124 offset:4096
    ds_read_b64_tr_b16 v[226:227], v124 offset:5120
    v_exp_f32 v53, v53
    v_exp_f32 v54, v54
    v_exp_f32 v55, v55
    v_mfma_f32_32x32x16_bf16 v[160:175], v[216:219], v[204:207], v[160:175]
    ds_read_b64_tr_b16 v[228:229], v125 offset:4096
    ds_read_b64_tr_b16 v[230:231], v125 offset:5120
    ds_read_b64_tr_b16 v[232:233], v124 offset:6144
    ds_read_b64_tr_b16 v[234:235], v124 offset:7168
    v_exp_f32 v56, v56
    v_exp_f32 v57, v57
    v_exp_f32 v58, v58
    v_smfmac_f32_32x32x32_bf16 v[80:95], v[112:115], v[48:55], v19
    ds_read_b64_tr_b16 v[236:237], v125 offset:6144
    ds_read_b64_tr_b16 v[238:239], v125 offset:7168
    v_exp_f32 v59, v59
    v_exp_f32 v60, v60
    v_exp_f32 v61, v61
    v_mfma_f32_32x32x16_bf16 v[176:191], v[220:223], v[204:207], v[176:191]
    ds_read_b64_tr_b16 v[192:193], v124 offset:8192
    ds_read_b64_tr_b16 v[194:195], v124 offset:9216
    v_exp_f32 v62, v62
    v_exp_f32 v63, v63
    v_exp_f32 v32, v32
    v_exp_f32 v33, v33
    v_smfmac_f32_32x32x32_bf16 v[80:95], v[116:119], v[56:63], v19
    s_mov_b64 exec, s[72:73]
    ds_read_b128 v[112:115], v21 offset:6144
    ds_read_b128 v[116:119], v21 offset:6656
    s_mov_b64 exec, -1
    v_exp_f32 v34, v34
    v_exp_f32 v35, v35
    v_exp_f32 v36, v36
    v_mfma_f32_32x32x16_bf16 v[48:63], v[96:99], v[12:15], 0
    ds_read_b128 v[100:103], v20 offset:6144
    v_exp_f32 v37, v37
    v_exp_f32 v38, v38
    v_exp_f32 v39, v39
    v_mfma_f32_32x32x16_bf16 v[128:143], v[216:219], v[200:203], v[128:143]
    v_exp_f32 v40, v40
    v_exp_f32 v41, v41
    v_exp_f32 v42, v42
    v_smfmac_f32_32x32x32_bf16 v[64:79], v[104:107], v[32:39], v19
    ds_write_b128 v126, v[160:163] offset:0
    ds_write_b128 v126, v[164:167] offset:1024
    v_exp_f32 v43, v43
    v_exp_f32 v44, v44
    v_exp_f32 v45, v45
    v_mfma_f32_32x32x16_bf16 v[144:159], v[220:223], v[200:203], v[144:159]
    ds_write_b128 v126, v[168:171] offset:2048
    v_exp_f32 v46, v46
    v_exp_f32 v47, v47
    v_exp_f32 v48, v48
    v_exp_f32 v49, v49
    v_smfmac_f32_32x32x32_bf16 v[64:79], v[108:111], v[40:47], v19
    s_waitcnt lgkmcnt(0)
    v_exp_f32 v50, v50
    v_exp_f32 v51, v51
    v_exp_f32 v52, v52
    v_mfma_f32_32x32x16_bf16 v[32:47], v[100:103], v[8:11], 0
    ds_write_b128 v126, v[172:175] offset:3072
    ds_read_b64_tr_b16 v[196:197], v125 offset:8192
    ds_read_b64_tr_b16 v[198:199], v125 offset:9216
    v_exp_f32 v53, v53
    v_exp_f32 v54, v54
    v_exp_f32 v55, v55
    ds_write_b128 v126, v[176:179] offset:4096
    ds_read_b64_tr_b16 v[208:209], v124 offset:10240
    ds_read_b64_tr_b16 v[210:211], v124 offset:11264
    v_exp_f32 v56, v56
    v_exp_f32 v57, v57
    v_exp_f32 v58, v58
    v_smfmac_f32_32x32x32_bf16 v[80:95], v[104:107], v[48:55], v19
    s_cbranch_vccz L_pr2430
    s_setprio 0
L_pr2430:
    ds_write_b128 v126, v[180:183] offset:5120
    ds_read_b64_tr_b16 v[212:213], v125 offset:10240
    ds_read_b64_tr_b16 v[214:215], v125 offset:11264
    v_exp_f32 v59, v59
    v_exp_f32 v60, v60
    v_exp_f32 v61, v61
    ds_write_b128 v16, v[184:187] offset:2048
    v_exp_f32 v62, v62
    v_exp_f32 v63, v63
    v_exp_f32 v32, v32
    v_exp_f32 v33, v33
    v_smfmac_f32_32x32x32_bf16 v[80:95], v[108:111], v[56:63], v19
    v_exp_f32 v34, v34
    v_exp_f32 v35, v35
    v_exp_f32 v36, v36
    v_mfma_f32_32x32x16_bf16 v[48:63], v[100:103], v[12:15], 0
    ds_write_b128 v16, v[188:191] offset:3072
    ds_read_b64_tr_b16 v[200:201], v124 offset:12288
    ds_read_b64_tr_b16 v[202:203], v124 offset:13312
    v_exp_f32 v37, v37
    v_exp_f32 v38, v38
    v_exp_f32 v39, v39
    ds_read_b64_tr_b16 v[204:205], v125 offset:12288
    ds_read_b64_tr_b16 v[206:207], v125 offset:13312
    v_exp_f32 v40, v40
    v_exp_f32 v41, v41
    v_exp_f32 v42, v42
    v_smfmac_f32_32x32x32_bf16 v[64:79], v[112:115], v[32:39], v19
    ds_read_b64_tr_b16 v[216:217], v124 offset:14336
    ds_read_b64_tr_b16 v[218:219], v124 offset:15360
    v_exp_f32 v43, v43
    v_exp_f32 v44, v44
    v_exp_f32 v45, v45
    ds_read_b64_tr_b16 v[220:221], v125 offset:14336
    ds_read_b64_tr_b16 v[222:223], v125 offset:15360
    v_exp_f32 v46, v46
    v_exp_f32 v47, v47
    v_exp_f32 v48, v48
    v_exp_f32 v49, v49
    v_smfmac_f32_32x32x32_bf16 v[64:79], v[116:119], v[40:47], v19
    v_exp_f32 v50, v50
    v_exp_f32 v51, v51
    v_exp_f32 v52, v52
    v_exp_f32 v53, v53
    v_exp_f32 v54, v54
    v_exp_f32 v55, v55
    v_exp_f32 v56, v56
    v_exp_f32 v57, v57
    v_exp_f32 v58, v58
    v_smfmac_f32_32x32x32_bf16 v[80:95], v[112:115], v[48:55], v19
    v_exp_f32 v59, v59
    v_exp_f32 v60, v60
    v_exp_f32 v61, v61
    v_exp_f32 v62, v62
    v_exp_f32 v63, v63
    v_add_u32 v20, s75, v2
    v_add_u32 v21, s46, v18
    v_smfmac_f32_32x32x32_bf16 v[80:95], v[116:119], v[56:63], v19
    s_mul_i32 s62, s99, 144
    s_lshl_b32 s63, s34, 3
    s_add_u32 s62, s62, s63
    s_add_u32 s62, s62, 112
    s_lshl_b32 s75, s62, 10
    s_add_u32 s101, s75, 4096
    s_mov_b32 s46, 0x1f800000
    s_mov_b32 s64, 0x7f000000
    v_sub_f32 v28, 1.0, v27
    v_xor_b32 v5, 0x4000, v16
    s_setprio 0
    s_mov_b32 s70, 1 << 16
    ds_write_b32 v17, v88
    ds_write_b128 v16, v[80:83]
    ds_write_b128 v16, v[84:87] offset:1024
    s_waitcnt lgkmcnt(0)
    s_barrier
    ds_read_b32 v40, v21
    ds_read_b128 v[32:35], v5
    ds_read_b128 v[36:39], v5 offset:1024
    ds_read_b128 v[160:163], v20 offset:0
    ds_read_b128 v[164:167], v20 offset:1024
    ds_read_b128 v[168:171], v20 offset:2048
    ds_read_b128 v[172:175], v20 offset:3072
    ds_read_b128 v[176:179], v20 offset:4096
    ds_read_b128 v[180:183], v20 offset:5120
    ds_read_b128 v[184:187], v5 offset:2048
    ds_read_b128 v[188:191], v5 offset:3072
    s_waitcnt lgkmcnt(10)
    v_add_f32 v72, v72, v40
    v_rcp_f32 v4, v72
    v_subrev_u32 v6, s46, v72
    v_cmp_le_u32 s[66:67], 2.0, v6
    s_waitcnt lgkmcnt(8)
    v_pk_add_f32 v[64:65], v[64:65], v[32:33]
    v_pk_add_f32 v[66:67], v[66:67], v[34:35]
    v_pk_add_f32 v[68:69], v[68:69], v[36:37]
    v_pk_add_f32 v[70:71], v[70:71], v[38:39]
    v_max3_f32 v6, |v64|, |v65|, |v66|
    v_max3_f32 v6, |v67|, |v68|, v6
    v_max3_f32 v6, |v69|, |v70|, v6
    v_max_f32 v6, |v71|, v6
    v_cmp_ngt_f32 vcc, s64, v6
    s_or_b64 s[66:67], s[66:67], vcc
    s_cbranch_scc1 L_fb
L_fin:
    v_mul_f32 v4, v4, v26
    v_pk_mul_f32 v[64:65], v[64:65], v[4:5] op_sel_hi:[1,0]
    v_pk_mul_f32 v[66:67], v[66:67], v[4:5] op_sel_hi:[1,0]
    v_pk_mul_f32 v[68:69], v[68:69], v[4:5] op_sel_hi:[1,0]
    v_pk_mul_f32 v[70:71], v[70:71], v[4:5] op_sel_hi:[1,0]
    v_cvt_pk_bf16_f32 v80, v64, v65
    v_cvt_pk_bf16_f32 v81, v66, v67
    v_cvt_pk_bf16_f32 v82, v68, v69
    v_cvt_pk_bf16_f32 v83, v70, v71
    buffer_store_dwordx4 v[80:83], v2, s[8:11], s65 offen sc1
    s_waitcnt lgkmcnt(0)
    v_pk_add_f32 v[128:129], v[128:129], v[160:161]
    v_pk_add_f32 v[130:131], v[130:131], v[162:163]
    v_pk_add_f32 v[132:133], v[132:133], v[164:165]
    v_pk_add_f32 v[134:135], v[134:135], v[166:167]
    v_pk_add_f32 v[136:137], v[136:137], v[168:169]
    v_pk_add_f32 v[138:139], v[138:139], v[170:171]
    v_pk_add_f32 v[140:141], v[140:141], v[172:173]
    v_pk_add_f32 v[142:143], v[142:143], v[174:175]
    v_pk_add_f32 v[144:145], v[144:145], v[176:177]
    v_pk_add_f32 v[146:147], v[146:147], v[178:179]
    v_pk_add_f32 v[148:149], v[148:149], v[180:181]
    v_pk_add_f32 v[150:151], v[150:151], v[182:183]
    v_pk_add_f32 v[152:153], v[152:153], v[184:185]
    v_pk_add_f32 v[154:155], v[154:155], v[186:187]
    v_pk_add_f32 v[156:157], v[156:157], v[188:189]
    v_pk_add_f32 v[158:159], v[158:159], v[190:191]
    v_pk_mul_f32 v[128:129], v[128:129], v[28:29] op_sel_hi:[1,0]
    v_pk_mul_f32 v[130:131], v[130:131], v[28:29] op_sel_hi:[1,0]
    v_pk_mul_f32 v[132:133], v[132:133], v[28:29] op_sel_hi:[1,0]
    v_pk_mul_f32 v[134:135], v[134:135], v[28:29] op_sel_hi:[1,0]
    v_pk_mul_f32 v[136:137], v[136:137], v[28:29] op_sel_hi:[1,0]
    v_pk_mul_f32 v[138:139], v[138:139], v[28:29] op_sel_hi:[1,0]
    v_pk_mul_f32 v[140:141], v[140:141], v[28:29] op_sel_hi:[1,0]
    v_pk_mul_f32 v[142:143], v[142:143], v[28:29] op_sel_hi:[1,0]
    v_pk_mul_f32 v[144:145], v[144:145], v[28:29] op_sel_hi:[1,0]
    v_pk_mul_f32 v[146:147], v[146:147], v[28:29] op_sel_hi:[1,0]
    v_pk_mul_f32 v[148:149], v[148:149], v[28:29] op_sel_hi:[1,0]
    v_pk_mul_f32 v[150:151], v[150:151], v[28:29] op_sel_hi:[1,0]
    v_pk_mul_f32 v[152:153], v[152:153], v[28:29] op_sel_hi:[1,0]
    v_pk_mul_f32 v[154:155], v[154:155], v[28:29] op_sel_hi:[1,0]
    v_pk_mul_f32 v[156:157], v[156:157], v[28:29] op_sel_hi:[1,0]
    v_pk_mul_f32 v[158:159], v[158:159], v[28:29] op_sel_hi:[1,0]
    v_and_b32 v5, 31, v0
    v_and_b32 v6, 15, v0
    v_xor_b32 v6, v6, v7
    v_lshlrev_b32 v6, 4, v6
    v_lshl_add_u32 v6, v5, 8, v6
    s_lshl_b32 s65, s33, 13
    s_add_u32 s64, s74, s65
    v_add_u32 v8, s64, v6
    v_xor_b32 v9, 32, v8
    v_xor_b32 v10, 64, v8
    v_xor_b32 v11, 96, v8
    v_xor_b32 v12, 128, v8
    v_xor_b32 v13, 160, v8
    v_xor_b32 v14, 192, v8
    v_xor_b32 v15, 224, v8
    v_lshrrev_b32 v5, 3, v0
    s_lshl_b32 s64, s32, 3
    v_add_u32 v5, s64, v5
    v_and_b32 v6, 7, v0
    v_lshlrev_b32 v16, 4, v6
    v_lshlrev_b32 v6, 1, v6
    v_and_b32 v17, 15, v5
    v_xor_b32 v6, v6, v17
    v_lshlrev_b32 v6, 4, v6
    v_lshl_add_u32 v6, v5, 8, v6
    v_xor_b32 v17, 16, v6
    v_add_u32 v22, 98304, v6
    v_add_u32 v21, 98304, v17
    v_lshl_add_u32 v16, v5, 10, v16
    s_lshl_b32 s64, s35, 16
    s_lshl_b32 s65, s71, 7
    s_add_u32 s64, s64, s65
    s_waitcnt vmcnt(0)
    buffer_load_dwordx4 v[96:99], v2, s[8:11], s75 offen offset:0 sc1
    buffer_load_dwordx4 v[100:103], v2, s[8:11], s75 offen offset:1024 sc1
    buffer_load_dwordx4 v[104:107], v2, s[8:11], s75 offen offset:2048 sc1
    buffer_load_dwordx4 v[108:111], v2, s[8:11], s75 offen offset:3072 sc1
    buffer_load_dwordx4 v[112:115], v2, s[8:11], s101 offen offset:0 sc1
    buffer_load_dwordx4 v[116:119], v2, s[8:11], s101 offen offset:1024 sc1
    buffer_load_dwordx4 v[120:123], v2, s[8:11], s101 offen offset:2048 sc1
    buffer_load_dwordx4 v[124:127], v2, s[8:11], s101 offen offset:3072 sc1
    s_waitcnt vmcnt(7)
L_oc0:
    v_max3_u32 v4, v96, v97, v98
    v_max_u32 v4, v4, v99
    v_cmp_eq_u32 vcc, -1, v4
    s_cbranch_vccnz L_or0
L_om0:
    v_mfma_f32_32x32x16_bf16 v[128:143], v[240:243], v[96:99], v[128:143]
    v_mfma_f32_32x32x16_bf16 v[144:159], v[244:247], v[96:99], v[144:159]
    s_waitcnt vmcnt(6)
L_oc1:
    v_max3_u32 v4, v100, v101, v102
    v_max_u32 v4, v4, v103
    v_cmp_eq_u32 vcc, -1, v4
    s_cbranch_vccnz L_or1
L_om1:
    v_mfma_f32_32x32x16_bf16 v[128:143], v[248:251], v[100:103], v[128:143]
    v_mfma_f32_32x32x16_bf16 v[144:159], v[252:255], v[100:103], v[144:159]
    s_waitcnt vmcnt(5)
L_oc2:
    v_max3_u32 v4, v104, v105, v106
    v_max_u32 v4, v4, v107
    v_cmp_eq_u32 vcc, -1, v4
    s_cbranch_vccnz L_or2
L_om2:
    v_mfma_f32_32x32x16_bf16 v[128:143], v[224:227], v[104:107], v[128:143]
    v_mfma_f32_32x32x16_bf16 v[144:159], v[228:231], v[104:107], v[144:159]
    s_waitcnt vmcnt(4)
L_oc3:
    v_max3_u32 v4, v108, v109, v110
    v_max_u32 v4, v4, v111
    v_cmp_eq_u32 vcc, -1, v4
    s_cbranch_vccnz L_or3
L_om3:
    v_mfma_f32_32x32x16_bf16 v[128:143], v[232:235], v[108:111], v[128:143]
    v_mfma_f32_32x32x16_bf16 v[144:159], v[236:239], v[108:111], v[144:159]
    s_waitcnt vmcnt(3)
L_oc4:
    v_max3_u32 v4, v112, v113, v114
    v_max_u32 v4, v4, v115
    v_cmp_eq_u32 vcc, -1, v4
    s_cbranch_vccnz L_or4
L_om4:
    v_mfma_f32_32x32x16_bf16 v[128:143], v[192:195], v[112:115], v[128:143]
    v_mfma_f32_32x32x16_bf16 v[144:159], v[196:199], v[112:115], v[144:159]
    s_waitcnt vmcnt(2)
L_oc5:
    v_max3_u32 v4, v116, v117, v118
    v_max_u32 v4, v4, v119
    v_cmp_eq_u32 vcc, -1, v4
    s_cbranch_vccnz L_or5
L_om5:
    v_mfma_f32_32x32x16_bf16 v[128:143], v[208:211], v[116:119], v[128:143]
    v_mfma_f32_32x32x16_bf16 v[144:159], v[212:215], v[116:119], v[144:159]
    s_waitcnt vmcnt(1)
L_oc6:
    v_max3_u32 v4, v120, v121, v122
    v_max_u32 v4, v4, v123
    v_cmp_eq_u32 vcc, -1, v4
    s_cbranch_vccnz L_or6
L_om6:
    v_mfma_f32_32x32x16_bf16 v[128:143], v[200:203], v[120:123], v[128:143]
    v_mfma_f32_32x32x16_bf16 v[144:159], v[204:207], v[120:123], v[144:159]
    s_waitcnt vmcnt(0)
L_oc7:
    v_max3_u32 v4, v124, v125, v126
    v_max_u32 v4, v4, v127
    v_cmp_eq_u32 vcc, -1, v4
    s_cbranch_vccnz L_or7
L_om7:
    v_mfma_f32_32x32x16_bf16 v[128:143], v[216:219], v[124:127], v[128:143]
    v_mfma_f32_32x32x16_bf16 v[144:159], v[220:223], v[124:127], v[144:159]
    s_nop 10
    ds_write_b128 v8, v[128:131]
    ds_write_b128 v9, v[132:135]
    ds_write_b128 v10, v[136:139]
    ds_write_b128 v11, v[140:143]
    ds_write_b128 v12, v[144:147]
    ds_write_b128 v13, v[148:151]
    ds_write_b128 v14, v[152:155]
    ds_write_b128 v15, v[156:159]
    s_waitcnt lgkmcnt(0)
    s_barrier
    ds_read_b128 v[32:35], v6 offset:0
    ds_read_b128 v[36:39], v17 offset:0
    ds_read_b128 v[40:43], v6 offset:16384
    ds_read_b128 v[44:47], v17 offset:16384
    ds_read_b128 v[48:51], v22 offset:0
    ds_read_b128 v[52:55], v21 offset:0
    ds_read_b128 v[56:59], v22 offset:16384
    ds_read_b128 v[60:63], v21 offset:16384
    s_waitcnt lgkmcnt(4)
    v_pk_add_f32 v[32:33], v[32:33], v[40:41]
    v_pk_add_f32 v[34:35], v[34:35], v[42:43]
    v_pk_add_f32 v[36:37], v[36:37], v[44:45]
    v_pk_add_f32 v[38:39], v[38:39], v[46:47]
    s_waitcnt lgkmcnt(2)
    v_pk_add_f32 v[32:33], v[32:33], v[48:49]
    v_pk_add_f32 v[34:35], v[34:35], v[50:51]
    v_pk_add_f32 v[36:37], v[36:37], v[52:53]
    v_pk_add_f32 v[38:39], v[38:39], v[54:55]
    s_waitcnt lgkmcnt(0)
    v_pk_add_f32 v[32:33], v[32:33], v[56:57]
    v_pk_add_f32 v[34:35], v[34:35], v[58:59]
    v_pk_add_f32 v[36:37], v[36:37], v[60:61]
    v_pk_add_f32 v[38:39], v[38:39], v[62:63]
    v_cvt_pk_bf16_f32 v64, v32, v33
    v_cvt_pk_bf16_f32 v65, v34, v35
    v_cvt_pk_bf16_f32 v66, v36, v37
    v_cvt_pk_bf16_f32 v67, v38, v39
    buffer_store_dwordx4 v[64:67], v16, s[20:23], s64 offen sc1
L_end:
    s_endpgm
L_or0:
    s_cmp_eq_u32 s70, 0
    s_cbranch_scc1 L_om0
    s_sub_u32 s70, s70, 1
    s_waitcnt vmcnt(0)
    s_sleep 2
    buffer_load_dwordx4 v[96:99], v2, s[8:11], s75 offen offset:0 sc1
    buffer_load_dwordx4 v[100:103], v2, s[8:11], s75 offen offset:1024 sc1
    buffer_load_dwordx4 v[104:107], v2, s[8:11], s75 offen offset:2048 sc1
    buffer_load_dwordx4 v[108:111], v2, s[8:11], s75 offen offset:3072 sc1
    buffer_load_dwordx4 v[112:115], v2, s[8:11], s101 offen offset:0 sc1
    buffer_load_dwordx4 v[116:119], v2, s[8:11], s101 offen offset:1024 sc1
    buffer_load_dwordx4 v[120:123], v2, s[8:11], s101 offen offset:2048 sc1
    buffer_load_dwordx4 v[124:127], v2, s[8:11], s101 offen offset:3072 sc1
    s_waitcnt vmcnt(0)
    s_branch L_oc0
L_or1:
    s_cmp_eq_u32 s70, 0
    s_cbranch_scc1 L_om1
    s_sub_u32 s70, s70, 1
    s_waitcnt vmcnt(0)
    s_sleep 2
    buffer_load_dwordx4 v[100:103], v2, s[8:11], s75 offen offset:1024 sc1
    buffer_load_dwordx4 v[104:107], v2, s[8:11], s75 offen offset:2048 sc1
    buffer_load_dwordx4 v[108:111], v2, s[8:11], s75 offen offset:3072 sc1
    buffer_load_dwordx4 v[112:115], v2, s[8:11], s101 offen offset:0 sc1
    buffer_load_dwordx4 v[116:119], v2, s[8:11], s101 offen offset:1024 sc1
    buffer_load_dwordx4 v[120:123], v2, s[8:11], s101 offen offset:2048 sc1
    buffer_load_dwordx4 v[124:127], v2, s[8:11], s101 offen offset:3072 sc1
    s_waitcnt vmcnt(0)
    s_branch L_oc1
L_or2:
    s_cmp_eq_u32 s70, 0
    s_cbranch_scc1 L_om2
    s_sub_u32 s70, s70, 1
    s_waitcnt vmcnt(0)
    s_sleep 2
    buffer_load_dwordx4 v[104:107], v2, s[8:11], s75 offen offset:2048 sc1
    buffer_load_dwordx4 v[108:111], v2, s[8:11], s75 offen offset:3072 sc1
    buffer_load_dwordx4 v[112:115], v2, s[8:11], s101 offen offset:0 sc1
    buffer_load_dwordx4 v[116:119], v2, s[8:11], s101 offen offset:1024 sc1
    buffer_load_dwordx4 v[120:123], v2, s[8:11], s101 offen offset:2048 sc1
    buffer_load_dwordx4 v[124:127], v2, s[8:11], s101 offen offset:3072 sc1
    s_waitcnt vmcnt(0)
    s_branch L_oc2
L_or3:
    s_cmp_eq_u32 s70, 0
    s_cbranch_scc1 L_om3
    s_sub_u32 s70, s70, 1
    s_waitcnt vmcnt(0)
    s_sleep 2
    buffer_load_dwordx4 v[108:111], v2, s[8:11], s75 offen offset:3072 sc1
    buffer_load_dwordx4 v[112:115], v2, s[8:11], s101 offen offset:0 sc1
    buffer_load_dwordx4 v[116:119], v2, s[8:11], s101 offen offset:1024 sc1
    buffer_load_dwordx4 v[120:123], v2, s[8:11], s101 offen offset:2048 sc1
    buffer_load_dwordx4 v[124:127], v2, s[8:11], s101 offen offset:3072 sc1
    s_waitcnt vmcnt(0)
    s_branch L_oc3
L_or4:
    s_cmp_eq_u32 s70, 0
    s_cbranch_scc1 L_om4
    s_sub_u32 s70, s70, 1
    s_waitcnt vmcnt(0)
    s_sleep 2
    buffer_load_dwordx4 v[112:115], v2, s[8:11], s101 offen offset:0 sc1
    buffer_load_dwordx4 v[116:119], v2, s[8:11], s101 offen offset:1024 sc1
    buffer_load_dwordx4 v[120:123], v2, s[8:11], s101 offen offset:2048 sc1
    buffer_load_dwordx4 v[124:127], v2, s[8:11], s101 offen offset:3072 sc1
    s_waitcnt vmcnt(0)
    s_branch L_oc4
L_or5:
    s_cmp_eq_u32 s70, 0
    s_cbranch_scc1 L_om5
    s_sub_u32 s70, s70, 1
    s_waitcnt vmcnt(0)
    s_sleep 2
    buffer_load_dwordx4 v[116:119], v2, s[8:11], s101 offen offset:1024 sc1
    buffer_load_dwordx4 v[120:123], v2, s[8:11], s101 offen offset:2048 sc1
    buffer_load_dwordx4 v[124:127], v2, s[8:11], s101 offen offset:3072 sc1
    s_waitcnt vmcnt(0)
    s_branch L_oc5
L_or6:
    s_cmp_eq_u32 s70, 0
    s_cbranch_scc1 L_om6
    s_sub_u32 s70, s70, 1
    s_waitcnt vmcnt(0)
    s_sleep 2
    buffer_load_dwordx4 v[120:123], v2, s[8:11], s101 offen offset:2048 sc1
    buffer_load_dwordx4 v[124:127], v2, s[8:11], s101 offen offset:3072 sc1
    s_waitcnt vmcnt(0)
    s_branch L_oc6
L_or7:
    s_cmp_eq_u32 s70, 0
    s_cbranch_scc1 L_om7
    s_sub_u32 s70, s70, 1
    s_waitcnt vmcnt(0)
    s_sleep 2
    buffer_load_dwordx4 v[124:127], v2, s[8:11], s101 offen offset:3072 sc1
    s_waitcnt vmcnt(0)
    s_branch L_oc7
L_lkv:
    s_mov_b32 s12, s40
    s_and_b32 s13, s41, 0xffff
    s_mov_b32 s14, 16384
    s_mov_b32 s15, 0x00020000
    s_mov_b32 s16, s42
    s_and_b32 s17, s43, 0xffff
    s_mov_b32 s18, 16384
    s_mov_b32 s19, 0x00020000
    s_and_b32 s64, s100, 1
    s_mov_b32 s70, 0
L_lk0:
    s_lshl_b32 s63, s28, 17
    s_lshl_b32 s62, s64, 16
    s_add_u32 s63, s63, s62
    s_lshl_b32 s62, s34, 8
    s_add_u32 s63, s63, s62
    s_lshl_b32 s62, s34, 15
    s_lshl_b32 s65, s64, 13
    s_add_u32 s62, s62, s65
    s_add_u32 m0, s62, 0
    s_add_u32 s65, s63, 0
    buffer_load_dwordx4 v3, s[4:7], s65 offen lds
    s_add_u32 m0, s62, 1024
    s_add_u32 s65, s63, 0
    buffer_load_dwordx4 v15, s[4:7], s65 offen lds
    s_add_u32 m0, s62, 2048
    s_add_u32 s65, s63, 16384
    buffer_load_dwordx4 v3, s[4:7], s65 offen lds
    s_add_u32 m0, s62, 3072
    s_add_u32 s65, s63, 16384
    buffer_load_dwordx4 v15, s[4:7], s65 offen lds
    s_add_u32 m0, s62, 4096
    s_add_u32 s65, s63, 32768
    buffer_load_dwordx4 v3, s[4:7], s65 offen lds
    s_add_u32 m0, s62, 5120
    s_add_u32 s65, s63, 32768
    buffer_load_dwordx4 v15, s[4:7], s65 offen lds
    s_add_u32 m0, s62, 6144
    s_add_u32 s65, s63, 49152
    buffer_load_dwordx4 v3, s[4:7], s65 offen lds
    s_add_u32 m0, s62, 7168
    s_add_u32 s65, s63, 49152
    buffer_load_dwordx4 v15, s[4:7], s65 offen lds
    s_add_u32 m0, s62, 16384
    s_add_u32 s65, s63, 128
    buffer_load_dwordx4 v3, s[4:7], s65 offen lds
    s_add_u32 m0, s62, 17408
    s_add_u32 s65, s63, 128
    buffer_load_dwordx4 v15, s[4:7], s65 offen lds
    s_add_u32 m0, s62, 18432
    s_add_u32 s65, s63, 16512
    buffer_load_dwordx4 v3, s[4:7], s65 offen lds
    s_add_u32 m0, s62, 19456
    s_add_u32 s65, s63, 16512
    buffer_load_dwordx4 v15, s[4:7], s65 offen lds
    s_add_u32 m0, s62, 20480
    s_add_u32 s65, s63, 32896
    buffer_load_dwordx4 v3, s[4:7], s65 offen lds
    s_add_u32 m0, s62, 21504
    s_add_u32 s65, s63, 32896
    buffer_load_dwordx4 v15, s[4:7], s65 offen lds
    s_add_u32 m0, s62, 22528
    s_add_u32 s65, s63, 49280
    buffer_load_dwordx4 v3, s[4:7], s65 offen lds
    s_add_u32 m0, s62, 23552
    s_add_u32 s65, s63, 49280
    buffer_load_dwordx4 v15, s[4:7], s65 offen lds
    s_cmp_lg_u32 s70, 0
    s_cbranch_scc1 L_lk1
    s_lshl_b32 s62, s34, 13
    s_add_u32 m0, s62, 131072
    s_add_u32 s65, s76, 0
    buffer_load_dwordx4 v2, s[12:15], s65 offen lds
    buffer_load_dwordx4 v2, s[12:15], s65 offen offset:1024 lds
    s_add_u32 m0, s62, 133120
    s_add_u32 s65, s76, 0
    buffer_load_dwordx4 v2, s[16:19], s65 offen lds
    buffer_load_dwordx4 v2, s[16:19], s65 offen offset:1024 lds
    s_add_u32 m0, s62, 135168
    s_add_u32 s65, s76, 2048
    buffer_load_dwordx4 v2, s[12:15], s65 offen lds
    buffer_load_dwordx4 v2, s[12:15], s65 offen offset:1024 lds
    s_add_u32 m0, s62, 137216
    s_add_u32 s65, s76, 2048
    buffer_load_dwordx4 v2, s[16:19], s65 offen lds
    buffer_load_dwordx4 v2, s[16:19], s65 offen offset:1024 lds
    s_waitcnt vmcnt(0)
    s_barrier
    s_xor_b32 s64, s64, 1
    s_mov_b32 s70, 1
    s_branch L_lk0
L_lk1:
    s_cmp_eq_u32 s33, 0
    s_cselect_b32 s62, 98304, 0
    v_add_u32 v20, s62, v2
    v_and_b32 v16, 15, v0
    v_lshlrev_b32 v16, 4, v16
    v_lshl_add_u32 v16, v7, 8, v16
    s_add_u32 s62, s62, 1024
    v_add_u32 v21, s62, v16
    v_mov_b32 v19, 0xdddd
    s_mov_b32 s72, 0xffff
    s_mov_b32 s73, 0xffff
    s_and_b32 s62, s2, 3
    s_bfe_u32 s35, s2, 0x30003
    s_lshl_b32 s35, s35, 2
    s_add_u32 s35, s35, s62
    s_lshr_b32 s71, s2, 6
    s_and_b32 s62, s2, 4
    s_add_u32 s71, s71, s62
    v_lshrrev_b32 v5, 3, v0
    v_bfe_u32 v6, v0, 2, 1
    v_xor_b32 v6, v6, v14
    v_lshlrev_b32 v6, 6, v6
    v_lshl_add_u32 v24, v5, 10, v6
    v_and_b32 v17, 3, v0
    v_lshl_add_u32 v24, v17, 4, v24
    s_lshl_b32 s62, s71, 7
    v_add_u32 v24, s62, v24
    v_bfe_u32 v5, v0, 2, 2
    v_lshl_add_u32 v6, v7, 2, v5
    v_lshlrev_b32 v6, 7, v6
    v_bfe_u32 v5, v0, 3, 1
    v_lshl_add_u32 v6, v5, 6, v6
    v_lshl_add_u32 v6, v14, 5, v6
    v_lshl_add_u32 v25, v17, 3, v6
    s_lshl_b32 s101, s32, 12
    s_add_u32 s101, s101, 65536
    v_add_u32 v22, s101, v25
    v_xor_b32 v23, 64, v22
    s_lshl_b32 s62, s34, 12
    s_add_u32 s62, s62, 147456
    v_add_u32 v16, s62, v2
    s_lshr_b32 s62, s35, 1
    s_sub_u32 s62, s62, s28
    v_mul_i32_i24 v17, s62, v7
    v_add_u32 v17, s28, v17
    v_lshlrev_b32 v17, 11, v17
    v_and_b32 v5, 0x780, v29
    v_or_b32 v17, v17, v5
    v_and_b32 v5, 27, v0
    v_cmp_eq_u32 vcc, 16, v5
    v_mov_b32 v5, 0x3f803f80
    s_nop 0
    v_cndmask_b32 v26, 0, v5, vcc
    v_mov_b32 v56, 0
    v_mov_b32 v57, 0
    v_mov_b32 v58, 0
    v_mov_b32 v59, 0
    v_mov_b32 v60, 0
    v_mov_b32 v61, 0
    v_mov_b32 v62, 0
    v_mov_b32 v63, 0
    v_mfma_f32_32x32x16_bf16 v[64:79], v[56:59], v[56:59], 0
    v_mfma_f32_32x32x16_bf16 v[80:95], v[56:59], v[56:59], 0
    v_mov_b32 v104, v26
    v_mov_b32 v105, v26
    v_mov_b32 v106, v26
    v_mov_b32 v107, v26
    v_mov_b32 v108, v26
    v_mov_b32 v109, v26
    v_mov_b32 v110, v26
    v_mov_b32 v111, v26
    v_mov_b32 v112, v26
    v_mov_b32 v113, v26
    v_mov_b32 v114, v26
    v_mov_b32 v115, v26
    v_mov_b32 v116, v26
    v_mov_b32 v117, v26
    v_mov_b32 v118, v26
    v_mov_b32 v119, v26
    v_add_u32 v120, 15360, v24
    v_add_u32 v121, 7168, v24
    s_barrier
    buffer_load_dword v30, v8, s[24:27], 0 offen sc1
    s_add_u32 m0, s69, 131072
    s_mov_b32 s65, 0
    buffer_load_dwordx4 v12, s[20:23], s65 offen lds
    s_add_u32 m0, s69, 135168
    s_mov_b32 s65, 65536
    buffer_load_dwordx4 v12, s[20:23], s65 offen lds
    s_add_u32 m0, s69, 139264
    s_mov_b32 s65, 131072
    buffer_load_dwordx4 v12, s[20:23], s65 offen lds
    s_add_u32 m0, s69, 143360
    s_mov_b32 s65, 196608
    buffer_load_dwordx4 v12, s[20:23], s65 offen lds
    s_add_u32 m0, s69, 147456
    s_mov_b32 s65, 262144
    buffer_load_dwordx4 v12, s[20:23], s65 offen lds
    s_add_u32 m0, s69, 151552
    s_mov_b32 s65, 327680
    buffer_load_dwordx4 v12, s[20:23], s65 offen lds
    s_add_u32 m0, s69, 155648
    s_mov_b32 s65, 393216
    buffer_load_dwordx4 v12, s[20:23], s65 offen lds
    s_add_u32 m0, s69, 159744
    s_mov_b32 s65, 458752
    buffer_load_dwordx4 v12, s[20:23], s65 offen lds
    s_waitcnt vmcnt(0)
    s_barrier
    s_mov_b32 s8, s60
    s_and_b32 s9, s61, 0xffff
    s_mov_b32 s10, 9617408
    s_mov_b32 s11, 0x00020000
    s_mov_b32 s74, 9576448
    s_mov_b32 s70, 1048576
L_kvc2:
    v_cmp_ne_u32 vcc, 0, v30
    s_cmp_eq_u64 vcc, -1
    s_cbranch_scc1 L_kvc2_ok
    s_sub_u32 s70, s70, 1
    s_cbranch_scc1 L_kvc2_ok
    s_sleep 12
    buffer_load_dword v30, v8, s[24:27], 0 offen sc1
    s_waitcnt vmcnt(0)
    s_branch L_kvc2
L_kvc2_ok:
    buffer_load_dwordx2 v[30:31], v29, s[8:11], s74 offen sc1
    s_waitcnt vmcnt(0)
    s_barrier
    s_branch L_ld6
L_ckv:
    s_getpc_b64 s[66:67]
L_cpf:
    s_sub_u32 s66, s66, L_cpf - L_start
    s_subb_u32 s67, s67, 0
    s_lshl_b32 s62, s34, 13
    v_add_u32 v5, s62, v29
    v_min_u32 v5, 20096, v5
    global_load_dword v95, v5, s[66:67]
    s_and_b32 s62, s100, 1
    s_lshl_b32 s62, s62, 1
    s_and_b32 s63, s34, 1
    s_add_u32 s64, s62, s63
    s_sub_u32 s62, s64, s34
    s_lshl_b32 s62, s62, 12
    v_and_b32 v5, 31, v0
    v_bfe_u32 v6, v0, 1, 3
    v_xor_b32 v6, v6, v7
    v_lshlrev_b32 v6, 4, v6
    v_lshl_add_u32 v245, v5, 7, v6
    s_lshl_b32 s63, s34, 12
    v_add_u32 v245, s63, v245
    v_xor_b32 v246, 32, v245
    v_xor_b32 v247, 64, v245
    v_xor_b32 v248, 0x60, v245
    v_add_u32 v240, s62, v245
    v_add_u32 v241, s62, v246
    v_add_u32 v242, s62, v247
    v_add_u32 v243, s62, v248
    v_bfe_u32 v6, v0, 2, 2
    v_lshl_add_u32 v5, v7, 3, v6
    v_lshlrev_b32 v8, 6, v5
    v_lshl_add_u32 v8, v14, 5, v8
    v_lshl_add_u32 v8, v9, 3, v8
    v_add_u32 v249, 131072, v8
    v_lshlrev_b32 v5, 5, v5
    v_lshl_add_u32 v5, v14, 11, v5
    v_and_b32 v6, 3, v0
    v_lshl_add_u32 v5, v6, 3, v5
    v_add_u32 v244, 131072, v5
    s_lshl_b32 s62, s28, 2
    s_add_u32 s64, s64, s62
    v_mov_b32 v8, 0
    s_lshl_b32 s63, s64, 13
    s_add_u32 s63, s63, 9584640
    s_cmp_ge_u32 s34, 2
    s_cselect_b32 s63, 9617408, s63
    buffer_store_dwordx4 v[84:87], v29, s[8:11], s63 offen sc1
    s_lshl_b32 s66, s64, 11
    s_add_u32 s66, s66, 9437184
    s_lshl_b32 s67, s64, 7
    s_add_u32 s67, s67, 9576448
    s_barrier
    buffer_load_dword v30, v8, s[24:27], 0 offen sc1
    s_cmp_ge_u32 s34, 2
    s_cbranch_scc1 L_ckb
    s_mov_b32 s70, 3
L_ck:
    ds_read_b128 v[128:131], v240 offset:0
    ds_read_b64_tr_b16 v[132:133], v244 offset:0
    ds_read_b64_tr_b16 v[134:135], v244 offset:128
    ds_read_b128 v[136:139], v241 offset:0
    ds_read_b64_tr_b16 v[140:141], v244 offset:512
    ds_read_b64_tr_b16 v[142:143], v244 offset:640
    ds_read_b128 v[144:147], v242 offset:0
    ds_read_b64_tr_b16 v[148:149], v244 offset:1024
    ds_read_b64_tr_b16 v[150:151], v244 offset:1152
    ds_read_b128 v[152:155], v243 offset:0
    ds_read_b64_tr_b16 v[156:157], v244 offset:1536
    ds_read_b64_tr_b16 v[158:159], v244 offset:1664
    s_sub_u32 s70, s70, 1
    s_waitcnt lgkmcnt(9)
    v_mfma_f32_32x32x16_bf16 v[96:111], v[132:135], v[128:131], v[96:111]
    ds_read_b128 v[160:163], v240 offset:16384
    ds_read_b64_tr_b16 v[164:165], v244 offset:4096
    ds_read_b64_tr_b16 v[166:167], v244 offset:4224
    s_waitcnt lgkmcnt(9)
    v_mfma_f32_32x32x16_bf16 v[96:111], v[140:143], v[136:139], v[96:111]
    ds_read_b128 v[168:171], v241 offset:16384
    ds_read_b64_tr_b16 v[172:173], v244 offset:4608
    ds_read_b64_tr_b16 v[174:175], v244 offset:4736
    s_waitcnt lgkmcnt(9)
    v_mfma_f32_32x32x16_bf16 v[96:111], v[148:151], v[144:147], v[96:111]
    ds_read_b128 v[176:179], v242 offset:16384
    ds_read_b64_tr_b16 v[180:181], v244 offset:5120
    ds_read_b64_tr_b16 v[182:183], v244 offset:5248
    s_waitcnt lgkmcnt(9)
    v_mfma_f32_32x32x16_bf16 v[96:111], v[156:159], v[152:155], v[96:111]
    ds_read_b128 v[184:187], v243 offset:16384
    ds_read_b64_tr_b16 v[188:189], v244 offset:5632
    ds_read_b64_tr_b16 v[190:191], v244 offset:5760
    s_waitcnt lgkmcnt(9)
    v_mfma_f32_32x32x16_bf16 v[96:111], v[164:167], v[160:163], v[96:111]
    v_add_u32 v240, 32768, v240
    v_add_u32 v241, 32768, v241
    v_add_u32 v242, 32768, v242
    v_add_u32 v243, 32768, v243
    v_add_u32 v244, 8192, v244
    s_waitcnt lgkmcnt(6)
    v_mfma_f32_32x32x16_bf16 v[96:111], v[172:175], v[168:171], v[96:111]
    s_waitcnt lgkmcnt(3)
    v_mfma_f32_32x32x16_bf16 v[96:111], v[180:183], v[176:179], v[96:111]
    s_waitcnt lgkmcnt(0)
    v_mfma_f32_32x32x16_bf16 v[96:111], v[188:191], v[184:187], v[96:111]
    s_cbranch_scc0 L_ck
    v_and_b32 v5, 0x33, v0
    v_bfe_u32 v6, v0, 2, 1
    v_lshl_or_b32 v5, v6, 3, v5
    v_bfe_u32 v6, v0, 3, 1
    v_lshl_or_b32 v5, v6, 2, v5
    v_lshlrev_b32 v5, 4, v5
    s_nop 6
    v_cvt_pk_bf16_f32 v80, v96, v97
    v_cvt_pk_bf16_f32 v81, v98, v99
    v_cvt_pk_bf16_f32 v82, v100, v101
    v_cvt_pk_bf16_f32 v83, v102, v103
    buffer_store_dwordx4 v[80:83], v5, s[8:11], s66 offen sc1
    s_branch L_ckf
L_ckb:
    s_mov_b32 s70, 3
L_cv:
    ds_read_b128 v[128:131], v240 offset:0
    ds_read_b64_tr_b16 v[132:133], v244 offset:0
    ds_read_b64_tr_b16 v[134:135], v244 offset:128
    ds_read_b128 v[136:139], v241 offset:0
    ds_read_b64_tr_b16 v[140:141], v244 offset:512
    ds_read_b64_tr_b16 v[142:143], v244 offset:640
    ds_read_b128 v[144:147], v242 offset:0
    ds_read_b64_tr_b16 v[148:149], v244 offset:1024
    ds_read_b64_tr_b16 v[150:151], v244 offset:1152
    ds_read_b128 v[152:155], v243 offset:0
    ds_read_b64_tr_b16 v[156:157], v244 offset:1536
    ds_read_b64_tr_b16 v[158:159], v244 offset:1664
    s_sub_u32 s70, s70, 1
    s_waitcnt lgkmcnt(9)
    v_mfma_f32_32x32x16_bf16 v[96:111], v[128:131], v[132:135], v[96:111]
    ds_read_b128 v[160:163], v240 offset:16384
    ds_read_b64_tr_b16 v[164:165], v244 offset:4096
    ds_read_b64_tr_b16 v[166:167], v244 offset:4224
    s_waitcnt lgkmcnt(9)
    v_mfma_f32_32x32x16_bf16 v[96:111], v[136:139], v[140:143], v[96:111]
    ds_read_b128 v[168:171], v241 offset:16384
    ds_read_b64_tr_b16 v[172:173], v244 offset:4608
    ds_read_b64_tr_b16 v[174:175], v244 offset:4736
    s_waitcnt lgkmcnt(9)
    v_mfma_f32_32x32x16_bf16 v[96:111], v[144:147], v[148:151], v[96:111]
    ds_read_b128 v[176:179], v242 offset:16384
    ds_read_b64_tr_b16 v[180:181], v244 offset:5120
    ds_read_b64_tr_b16 v[182:183], v244 offset:5248
    s_waitcnt lgkmcnt(9)
    v_mfma_f32_32x32x16_bf16 v[96:111], v[152:155], v[156:159], v[96:111]
    ds_read_b128 v[184:187], v243 offset:16384
    ds_read_b64_tr_b16 v[188:189], v244 offset:5632
    ds_read_b64_tr_b16 v[190:191], v244 offset:5760
    s_waitcnt lgkmcnt(9)
    v_mfma_f32_32x32x16_bf16 v[96:111], v[160:163], v[164:167], v[96:111]
    v_add_u32 v240, 32768, v240
    v_add_u32 v241, 32768, v241
    v_add_u32 v242, 32768, v242
    v_add_u32 v243, 32768, v243
    v_add_u32 v244, 8192, v244
    s_waitcnt lgkmcnt(6)
    v_mfma_f32_32x32x16_bf16 v[96:111], v[168:171], v[172:175], v[96:111]
    s_waitcnt lgkmcnt(3)
    v_mfma_f32_32x32x16_bf16 v[96:111], v[176:179], v[180:183], v[96:111]
    s_waitcnt lgkmcnt(0)
    v_mfma_f32_32x32x16_bf16 v[96:111], v[184:187], v[188:191], v[96:111]
    s_cbranch_scc0 L_cv
    v_and_b32 v5, 15, v0
    v_lshlrev_b32 v5, 4, v5
    v_lshl_add_u32 v5, v7, 8, v5
    s_add_u32 s67, s67, 4
    s_mov_b32 s62, 0xffff0000
    s_mov_b32 s63, 0xffff0000
    s_nop 6
    v_cvt_pk_bf16_f32 v80, v96, v97
    v_cvt_pk_bf16_f32 v81, v98, v99
    v_cvt_pk_bf16_f32 v82, v100, v101
    v_cvt_pk_bf16_f32 v83, v102, v103
    v_cvt_pk_bf16_f32 v84, v104, v105
    v_cvt_pk_bf16_f32 v85, v106, v107
    v_cvt_pk_bf16_f32 v86, v108, v109
    v_cvt_pk_bf16_f32 v87, v110, v111
    s_mov_b64 exec, s[62:63]
    buffer_store_dwordx4 v[80:83], v5, s[8:11], s66 offen offset:1024 sc1
    buffer_store_dwordx4 v[84:87], v5, s[8:11], s66 offen offset:1536 sc1
    s_mov_b64 exec, -1
L_ckf:
    v_mov_b32 v6, 1
    s_waitcnt vmcnt(0)
    s_mov_b32 s70, 1048576
L_pvc:
    v_cmp_ne_u32 vcc, 0, v30
    s_cmp_eq_u64 vcc, -1
    s_cbranch_scc1 L_pvc_ok
    s_sub_u32 s70, s70, 1
    s_cbranch_scc1 L_pvc_ok
    s_sleep 12
    buffer_load_dword v30, v8, s[24:27], 0 offen sc1
    s_waitcnt vmcnt(0)
    s_branch L_pvc
L_pvc_ok:
    s_mov_b64 exec, 1
    buffer_store_dword v6, v8, s[8:11], s67 offen sc1
    s_mov_b64 exec, -1
L_cke:
    s_mov_b32 s20, s54
    s_and_b32 s21, s55, 0xffff
    s_mov_b32 s22, 1024
    s_mov_b32 s23, 0x00020000
    s_lshl_b32 s77, s28, 1
    s_and_b32 s63, s100, 1
    s_add_u32 s77, s77, s63
    s_lshl_b32 s77, s77, 2
    s_add_u32 s77, s77, s34
    s_lshl_b32 s63, s77, 14
    v_lshlrev_b32 v5, 5, v0
    v_and_b32 v6, 0x3ff, v5
    buffer_load_dwordx4 v[40:43], v6, s[20:23], 0 offen
    buffer_load_dwordx4 v[44:47], v6, s[20:23], 0 offen offset:16
    buffer_load_dwordx4 v[128:131], v5, s[4:7], s63 offen offset:0
    buffer_load_dwordx4 v[132:135], v5, s[4:7], s63 offen offset:16
    buffer_load_dwordx4 v[136:139], v5, s[4:7], s63 offen offset:2048
    buffer_load_dwordx4 v[140:143], v5, s[4:7], s63 offen offset:2064
    s_add_u32 s63, s63, 4096
    buffer_load_dwordx4 v[144:147], v5, s[4:7], s63 offen offset:0
    buffer_load_dwordx4 v[148:151], v5, s[4:7], s63 offen offset:16
    buffer_load_dwordx4 v[152:155], v5, s[4:7], s63 offen offset:2048
    buffer_load_dwordx4 v[156:159], v5, s[4:7], s63 offen offset:2064
    s_add_u32 s63, s63, 4096
    buffer_load_dwordx4 v[160:163], v5, s[4:7], s63 offen offset:0
    buffer_load_dwordx4 v[164:167], v5, s[4:7], s63 offen offset:16
    buffer_load_dwordx4 v[168:171], v5, s[4:7], s63 offen offset:2048
    buffer_load_dwordx4 v[172:175], v5, s[4:7], s63 offen offset:2064
    s_add_u32 s63, s63, 4096
    buffer_load_dwordx4 v[176:179], v5, s[4:7], s63 offen offset:0
    buffer_load_dwordx4 v[180:183], v5, s[4:7], s63 offen offset:16
    buffer_load_dwordx4 v[184:187], v5, s[4:7], s63 offen offset:2048
    buffer_load_dwordx4 v[188:191], v5, s[4:7], s63 offen offset:2064
    s_barrier
    v_mov_b32 v48, 0
    v_mov_b32 v49, 0
    v_mov_b32 v50, 0
    v_mov_b32 v51, 0
    v_mov_b32 v52, 0
    v_mov_b32 v53, 0
    v_mov_b32 v54, 0
    v_mov_b32 v55, 0
    v_mov_b32 v88, -1
    v_mov_b32 v89, -1
    v_mov_b32 v90, -1
    v_mov_b32 v91, -1
    s_waitcnt vmcnt(0)
    s_mul_i32 s62, s64, 144
    s_lshr_b32 s63, s34, 1
    s_lshl_b32 s63, s63, 4
    s_add_u32 s62, s62, s63
    s_add_u32 s62, s62, 112
    s_lshl_b32 s76, s62, 10
    v_dot2c_f32_bf16 v48, v128, v40
    v_dot2c_f32_bf16 v49, v136, v40
    v_dot2c_f32_bf16 v50, v144, v40
    v_dot2c_f32_bf16 v51, v152, v40
    v_dot2c_f32_bf16 v52, v160, v40
    v_dot2c_f32_bf16 v53, v168, v40
    v_dot2c_f32_bf16 v54, v176, v40
    v_dot2c_f32_bf16 v55, v184, v40
    v_dot2c_f32_bf16 v48, v129, v41
    v_dot2c_f32_bf16 v49, v137, v41
    v_dot2c_f32_bf16 v50, v145, v41
    v_dot2c_f32_bf16 v51, v153, v41
    v_dot2c_f32_bf16 v52, v161, v41
    v_dot2c_f32_bf16 v53, v169, v41
    v_dot2c_f32_bf16 v54, v177, v41
    v_dot2c_f32_bf16 v55, v185, v41
    v_dot2c_f32_bf16 v48, v130, v42
    v_dot2c_f32_bf16 v49, v138, v42
    v_dot2c_f32_bf16 v50, v146, v42
    v_dot2c_f32_bf16 v51, v154, v42
    v_dot2c_f32_bf16 v52, v162, v42
    v_dot2c_f32_bf16 v53, v170, v42
    v_dot2c_f32_bf16 v54, v178, v42
    v_dot2c_f32_bf16 v55, v186, v42
    v_dot2c_f32_bf16 v48, v131, v43
    v_dot2c_f32_bf16 v49, v139, v43
    v_dot2c_f32_bf16 v50, v147, v43
    v_dot2c_f32_bf16 v51, v155, v43
    v_dot2c_f32_bf16 v52, v163, v43
    v_dot2c_f32_bf16 v53, v171, v43
    v_dot2c_f32_bf16 v54, v179, v43
    v_dot2c_f32_bf16 v55, v187, v43
    v_dot2c_f32_bf16 v48, v132, v44
    v_dot2c_f32_bf16 v49, v140, v44
    v_dot2c_f32_bf16 v50, v148, v44
    v_dot2c_f32_bf16 v51, v156, v44
    v_dot2c_f32_bf16 v52, v164, v44
    v_dot2c_f32_bf16 v53, v172, v44
    v_dot2c_f32_bf16 v54, v180, v44
    v_dot2c_f32_bf16 v55, v188, v44
    v_dot2c_f32_bf16 v48, v133, v45
    v_dot2c_f32_bf16 v49, v141, v45
    v_dot2c_f32_bf16 v50, v149, v45
    v_dot2c_f32_bf16 v51, v157, v45
    v_dot2c_f32_bf16 v52, v165, v45
    v_dot2c_f32_bf16 v53, v173, v45
    v_dot2c_f32_bf16 v54, v181, v45
    v_dot2c_f32_bf16 v55, v189, v45
    v_dot2c_f32_bf16 v48, v134, v46
    v_dot2c_f32_bf16 v49, v142, v46
    v_dot2c_f32_bf16 v50, v150, v46
    v_dot2c_f32_bf16 v51, v158, v46
    v_dot2c_f32_bf16 v52, v166, v46
    v_dot2c_f32_bf16 v53, v174, v46
    v_dot2c_f32_bf16 v54, v182, v46
    v_dot2c_f32_bf16 v55, v190, v46
    v_dot2c_f32_bf16 v48, v135, v47
    v_dot2c_f32_bf16 v49, v143, v47
    v_dot2c_f32_bf16 v50, v151, v47
    v_dot2c_f32_bf16 v51, v159, v47
    v_dot2c_f32_bf16 v52, v167, v47
    v_dot2c_f32_bf16 v53, v175, v47
    v_dot2c_f32_bf16 v54, v183, v47
    v_dot2c_f32_bf16 v55, v191, v47
    v_add_f32_dpp v48, v48, v48 row_shr:1 row_mask:0xf bank_mask:0xf bound_ctrl:0
    v_add_f32_dpp v49, v49, v49 row_shr:1 row_mask:0xf bank_mask:0xf bound_ctrl:0
    v_add_f32_dpp v50, v50, v50 row_shr:1 row_mask:0xf bank_mask:0xf bound_ctrl:0
    v_add_f32_dpp v51, v51, v51 row_shr:1 row_mask:0xf bank_mask:0xf bound_ctrl:0
    v_add_f32_dpp v52, v52, v52 row_shr:1 row_mask:0xf bank_mask:0xf bound_ctrl:0
    v_add_f32_dpp v53, v53, v53 row_shr:1 row_mask:0xf bank_mask:0xf bound_ctrl:0
    v_add_f32_dpp v54, v54, v54 row_shr:1 row_mask:0xf bank_mask:0xf bound_ctrl:0
    v_add_f32_dpp v55, v55, v55 row_shr:1 row_mask:0xf bank_mask:0xf bound_ctrl:0
    v_add_f32_dpp v48, v48, v48 row_shr:2 row_mask:0xf bank_mask:0xf bound_ctrl:0
    v_add_f32_dpp v49, v49, v49 row_shr:2 row_mask:0xf bank_mask:0xf bound_ctrl:0
    v_add_f32_dpp v50, v50, v50 row_shr:2 row_mask:0xf bank_mask:0xf bound_ctrl:0
    v_add_f32_dpp v51, v51, v51 row_shr:2 row_mask:0xf bank_mask:0xf bound_ctrl:0
    v_add_f32_dpp v52, v52, v52 row_shr:2 row_mask:0xf bank_mask:0xf bound_ctrl:0
    v_add_f32_dpp v53, v53, v53 row_shr:2 row_mask:0xf bank_mask:0xf bound_ctrl:0
    v_add_f32_dpp v54, v54, v54 row_shr:2 row_mask:0xf bank_mask:0xf bound_ctrl:0
    v_add_f32_dpp v55, v55, v55 row_shr:2 row_mask:0xf bank_mask:0xf bound_ctrl:0
    v_add_f32_dpp v48, v48, v48 row_shr:4 row_mask:0xf bank_mask:0xf bound_ctrl:0
    v_add_f32_dpp v49, v49, v49 row_shr:4 row_mask:0xf bank_mask:0xf bound_ctrl:0
    v_add_f32_dpp v50, v50, v50 row_shr:4 row_mask:0xf bank_mask:0xf bound_ctrl:0
    v_add_f32_dpp v51, v51, v51 row_shr:4 row_mask:0xf bank_mask:0xf bound_ctrl:0
    v_add_f32_dpp v52, v52, v52 row_shr:4 row_mask:0xf bank_mask:0xf bound_ctrl:0
    v_add_f32_dpp v53, v53, v53 row_shr:4 row_mask:0xf bank_mask:0xf bound_ctrl:0
    v_add_f32_dpp v54, v54, v54 row_shr:4 row_mask:0xf bank_mask:0xf bound_ctrl:0
    v_add_f32_dpp v55, v55, v55 row_shr:4 row_mask:0xf bank_mask:0xf bound_ctrl:0
    v_add_f32_dpp v48, v48, v48 row_shr:8 row_mask:0xf bank_mask:0xf bound_ctrl:0
    v_add_f32_dpp v49, v49, v49 row_shr:8 row_mask:0xf bank_mask:0xf bound_ctrl:0
    v_add_f32_dpp v50, v50, v50 row_shr:8 row_mask:0xf bank_mask:0xf bound_ctrl:0
    v_add_f32_dpp v51, v51, v51 row_shr:8 row_mask:0xf bank_mask:0xf bound_ctrl:0
    v_add_f32_dpp v52, v52, v52 row_shr:8 row_mask:0xf bank_mask:0xf bound_ctrl:0
    v_add_f32_dpp v53, v53, v53 row_shr:8 row_mask:0xf bank_mask:0xf bound_ctrl:0
    v_add_f32_dpp v54, v54, v54 row_shr:8 row_mask:0xf bank_mask:0xf bound_ctrl:0
    v_add_f32_dpp v55, v55, v55 row_shr:8 row_mask:0xf bank_mask:0xf bound_ctrl:0
    v_add_f32_dpp v48, v48, v48 row_bcast:15 row_mask:0xa bank_mask:0xf
    v_add_f32_dpp v49, v49, v49 row_bcast:15 row_mask:0xa bank_mask:0xf
    v_add_f32_dpp v50, v50, v50 row_bcast:15 row_mask:0xa bank_mask:0xf
    v_add_f32_dpp v51, v51, v51 row_bcast:15 row_mask:0xa bank_mask:0xf
    v_add_f32_dpp v52, v52, v52 row_bcast:15 row_mask:0xa bank_mask:0xf
    v_add_f32_dpp v53, v53, v53 row_bcast:15 row_mask:0xa bank_mask:0xf
    v_add_f32_dpp v54, v54, v54 row_bcast:15 row_mask:0xa bank_mask:0xf
    v_add_f32_dpp v55, v55, v55 row_bcast:15 row_mask:0xa bank_mask:0xf
    v_mul_f32 v48, s78, v48
    v_mul_f32 v49, s78, v49
    v_mul_f32 v50, s78, v50
    v_mul_f32 v51, s78, v51
    v_mul_f32 v52, s78, v52
    v_mul_f32 v53, s78, v53
    v_mul_f32 v54, s78, v54
    v_mul_f32 v55, s78, v55
    v_exp_f32 v48, v48
    v_exp_f32 v49, v49
    v_exp_f32 v50, v50
    v_exp_f32 v51, v51
    v_exp_f32 v52, v52
    v_exp_f32 v53, v53
    v_exp_f32 v54, v54
    v_exp_f32 v55, v55
    v_add_f32 v48, 1.0, v48
    v_add_f32 v49, 1.0, v49
    v_add_f32 v50, 1.0, v50
    v_add_f32 v51, 1.0, v51
    v_add_f32 v52, 1.0, v52
    v_add_f32 v53, 1.0, v53
    v_add_f32 v54, 1.0, v54
    v_add_f32 v55, 1.0, v55
    v_rcp_f32 v48, v48
    v_rcp_f32 v49, v49
    v_rcp_f32 v50, v50
    v_rcp_f32 v51, v51
    v_rcp_f32 v52, v52
    v_rcp_f32 v53, v53
    v_rcp_f32 v54, v54
    v_rcp_f32 v55, v55
    v_lshlrev_b32 v5, 2, v7
    s_lshl_b32 s63, s77, 6
    s_add_u32 s63, s63, 9568256
    s_mov_b32 s66, 0x80000000
    s_mov_b32 s67, 0x80000000
    s_mov_b64 exec, s[66:67]
    buffer_store_dword v48, v5, s[8:11], s63 offen offset:0 sc1
    buffer_store_dword v49, v5, s[8:11], s63 offen offset:8 sc1
    buffer_store_dword v50, v5, s[8:11], s63 offen offset:16 sc1
    buffer_store_dword v51, v5, s[8:11], s63 offen offset:24 sc1
    buffer_store_dword v52, v5, s[8:11], s63 offen offset:32 sc1
    buffer_store_dword v53, v5, s[8:11], s63 offen offset:40 sc1
    buffer_store_dword v54, v5, s[8:11], s63 offen offset:48 sc1
    buffer_store_dword v55, v5, s[8:11], s63 offen offset:56 sc1
    s_mov_b64 exec, -1
    s_barrier
    s_mov_b32 s70, 3
L_cq:
    ds_read_b128 v[128:131], v245 offset:0
    ds_read_b64_tr_b16 v[132:133], v249 offset:0
    ds_read_b64_tr_b16 v[134:135], v249 offset:256
    ds_read_b128 v[136:139], v246 offset:0
    ds_read_b64_tr_b16 v[140:141], v249 offset:1024
    ds_read_b64_tr_b16 v[142:143], v249 offset:1280
    ds_read_b128 v[144:147], v247 offset:0
    ds_read_b64_tr_b16 v[148:149], v249 offset:2048
    ds_read_b64_tr_b16 v[150:151], v249 offset:2304
    ds_read_b128 v[152:155], v248 offset:0
    ds_read_b64_tr_b16 v[156:157], v249 offset:3072
    ds_read_b64_tr_b16 v[158:159], v249 offset:3328
    s_sub_u32 s70, s70, 1
    s_waitcnt lgkmcnt(9)
    v_mfma_f32_32x32x16_bf16 v[224:239], v[132:135], v[128:131], v[224:239]
    ds_read_b128 v[160:163], v245 offset:16384
    ds_read_b64_tr_b16 v[164:165], v249 offset:4096
    ds_read_b64_tr_b16 v[166:167], v249 offset:4352
    s_waitcnt lgkmcnt(9)
    v_mfma_f32_32x32x16_bf16 v[224:239], v[140:143], v[136:139], v[224:239]
    ds_read_b128 v[168:171], v246 offset:16384
    ds_read_b64_tr_b16 v[172:173], v249 offset:5120
    ds_read_b64_tr_b16 v[174:175], v249 offset:5376
    s_waitcnt lgkmcnt(9)
    v_mfma_f32_32x32x16_bf16 v[224:239], v[148:151], v[144:147], v[224:239]
    ds_read_b128 v[176:179], v247 offset:16384
    ds_read_b64_tr_b16 v[180:181], v249 offset:6144
    ds_read_b64_tr_b16 v[182:183], v249 offset:6400
    s_waitcnt lgkmcnt(9)
    v_mfma_f32_32x32x16_bf16 v[224:239], v[156:159], v[152:155], v[224:239]
    ds_read_b128 v[184:187], v248 offset:16384
    ds_read_b64_tr_b16 v[188:189], v249 offset:7168
    ds_read_b64_tr_b16 v[190:191], v249 offset:7424
    s_waitcnt lgkmcnt(9)
    v_mfma_f32_32x32x16_bf16 v[224:239], v[164:167], v[160:163], v[224:239]
    v_add_u32 v245, 32768, v245
    v_add_u32 v246, 32768, v246
    v_add_u32 v247, 32768, v247
    v_add_u32 v248, 32768, v248
    v_add_u32 v249, 8192, v249
    s_waitcnt lgkmcnt(6)
    v_mfma_f32_32x32x16_bf16 v[224:239], v[172:175], v[168:171], v[224:239]
    s_waitcnt lgkmcnt(3)
    v_mfma_f32_32x32x16_bf16 v[224:239], v[180:183], v[176:179], v[224:239]
    s_waitcnt lgkmcnt(0)
    v_mfma_f32_32x32x16_bf16 v[224:239], v[188:191], v[184:187], v[224:239]
    s_cbranch_scc0 L_cq
    s_barrier
    s_nop 9
    v_mul_f32 v224, s82, v224
    v_mul_f32 v225, s82, v225
    v_mul_f32 v226, s82, v226
    v_mul_f32 v227, s82, v227
    v_mul_f32 v228, s82, v228
    v_mul_f32 v229, s82, v229
    v_mul_f32 v230, s82, v230
    v_mul_f32 v231, s82, v231
    v_mul_f32 v232, s82, v232
    v_mul_f32 v233, s82, v233
    v_mul_f32 v234, s82, v234
    v_mul_f32 v235, s82, v235
    v_mul_f32 v236, s82, v236
    v_mul_f32 v237, s82, v237
    v_mul_f32 v238, s82, v238
    v_mul_f32 v239, s82, v239
    v_cvt_pk_bf16_f32 v8, v224, v225
    v_cvt_pk_bf16_f32 v9, v226, v227
    v_cvt_pk_bf16_f32 v10, v228, v229
    v_cvt_pk_bf16_f32 v11, v230, v231
    v_cvt_pk_bf16_f32 v12, v232, v233
    v_cvt_pk_bf16_f32 v13, v234, v235
    v_cvt_pk_bf16_f32 v14, v236, v237
    v_cvt_pk_bf16_f32 v15, v238, v239
    ds_write_b128 v16, v[12:15]
    ds_write_b128 v16, v[8:11] offset:1024
    buffer_store_dwordx4 v[88:91], v2, s[8:11], s76 offen offset:0 sc1
    buffer_store_dwordx4 v[88:91], v2, s[8:11], s76 offen offset:1024 sc1
    buffer_store_dwordx4 v[88:91], v2, s[8:11], s76 offen offset:2048 sc1
    buffer_store_dwordx4 v[88:91], v2, s[8:11], s76 offen offset:3072 sc1
    s_add_u32 s76, s76, 4096
    buffer_store_dwordx4 v[88:91], v2, s[8:11], s76 offen offset:0 sc1
    buffer_store_dwordx4 v[88:91], v2, s[8:11], s76 offen offset:1024 sc1
    buffer_store_dwordx4 v[88:91], v2, s[8:11], s76 offen offset:2048 sc1
    buffer_store_dwordx4 v[88:91], v2, s[8:11], s76 offen offset:3072 sc1
    s_add_u32 s76, s76, 4096
    buffer_store_dwordx4 v[88:91], v2, s[8:11], s76 offen offset:0 sc1
    buffer_store_dwordx4 v[88:91], v2, s[8:11], s76 offen offset:1024 sc1
    buffer_store_dwordx4 v[88:91], v2, s[8:11], s76 offen offset:2048 sc1
    buffer_store_dwordx4 v[88:91], v2, s[8:11], s76 offen offset:3072 sc1
    s_add_u32 s76, s76, 4096
    buffer_store_dwordx4 v[88:91], v2, s[8:11], s76 offen offset:0 sc1
    buffer_store_dwordx4 v[88:91], v2, s[8:11], s76 offen offset:1024 sc1
    buffer_store_dwordx4 v[88:91], v2, s[8:11], s76 offen offset:2048 sc1
    buffer_store_dwordx4 v[88:91], v2, s[8:11], s76 offen offset:3072 sc1
    s_barrier
    s_waitcnt lgkmcnt(0)
    s_barrier
    s_barrier
    s_setprio 2
    s_branch L_qe
L_fb:
    v_mov_b32 v5, 0xff800000
    s_mov_b32 s62, 9437184
L_fb1:
    buffer_load_dwordx4 v[96:99], v2, s[8:11], s62 offen sc1
    s_waitcnt vmcnt(0)
    v_mfma_f32_32x32x16_bf16 v[32:47], v[96:99], v[8:11], 0
    s_nop 15
    v_max3_f32 v5, v32, v33, v5
    v_max3_f32 v5, v34, v35, v5
    v_max3_f32 v5, v36, v37, v5
    v_max3_f32 v5, v38, v39, v5
    v_max3_f32 v5, v40, v41, v5
    v_max3_f32 v5, v42, v43, v5
    v_max3_f32 v5, v44, v45, v5
    v_max3_f32 v5, v46, v47, v5
    s_add_u32 s62, s62, 2048
    s_cmp_lg_u32 s62, 9568256
    s_cbranch_scc1 L_fb1
    v_mov_b32 v6, v5
    s_nop 1
    v_permlane32_swap_b32 v5, v6
    s_nop 1
    v_max_f32 v5, v5, v6
    v_sub_f32 v48, 0, v5
    v_sub_f32 v49, 0, v5
    v_sub_f32 v50, 0, v5
    v_sub_f32 v51, 0, v5
    v_sub_f32 v52, 0, v5
    v_sub_f32 v53, 0, v5
    v_sub_f32 v54, 0, v5
    v_sub_f32 v55, 0, v5
    v_sub_f32 v56, 0, v5
    v_sub_f32 v57, 0, v5
    v_sub_f32 v58, 0, v5
    v_sub_f32 v59, 0, v5
    v_sub_f32 v60, 0, v5
    v_sub_f32 v61, 0, v5
    v_sub_f32 v62, 0, v5
    v_sub_f32 v63, 0, v5
    v_mov_b32 v64, 0
    v_mov_b32 v65, 0
    v_mov_b32 v66, 0
    v_mov_b32 v67, 0
    v_mov_b32 v68, 0
    v_mov_b32 v69, 0
    v_mov_b32 v70, 0
    v_mov_b32 v71, 0
    v_mov_b32 v72, 0
    v_mov_b32 v73, 0
    v_mov_b32 v74, 0
    v_mov_b32 v75, 0
    v_mov_b32 v76, 0
    v_mov_b32 v77, 0
    v_mov_b32 v78, 0
    v_mov_b32 v79, 0
    v_and_b32 v6, 15, v0
    v_lshlrev_b32 v6, 4, v6
    v_lshl_add_u32 v6, v7, 8, v6
    s_mov_b32 s62, 9437184
L_fb2:
    buffer_load_dwordx4 v[96:99], v2, s[8:11], s62 offen sc1
    s_mov_b64 exec, s[72:73]
    buffer_load_dwordx4 v[104:107], v6, s[8:11], s62 offen offset:1024 sc1
    buffer_load_dwordx4 v[108:111], v6, s[8:11], s62 offen offset:1536 sc1
    s_mov_b64 exec, -1
    s_waitcnt vmcnt(0)
    v_mfma_f32_32x32x16_bf16 v[32:47], v[96:99], v[8:11], v[48:63]
    s_nop 15
    v_exp_f32 v32, v32
    v_exp_f32 v33, v33
    v_exp_f32 v34, v34
    v_exp_f32 v35, v35
    v_exp_f32 v36, v36
    v_exp_f32 v37, v37
    v_exp_f32 v38, v38
    v_exp_f32 v39, v39
    v_exp_f32 v40, v40
    v_exp_f32 v41, v41
    v_exp_f32 v42, v42
    v_exp_f32 v43, v43
    v_exp_f32 v44, v44
    v_exp_f32 v45, v45
    v_exp_f32 v46, v46
    v_exp_f32 v47, v47
    s_nop 1
    v_smfmac_f32_32x32x32_bf16 v[64:79], v[104:107], v[32:39], v19
    v_smfmac_f32_32x32x32_bf16 v[64:79], v[108:111], v[40:47], v19
    s_nop 15
    s_add_u32 s62, s62, 2048
    s_cmp_lg_u32 s62, 9568256
    s_cbranch_scc1 L_fb2
    v_rcp_f32 v4, v72
    s_branch L_fin
L_code_end:
.section .rodata,"a"
.p2align 6
.amdhsa_kernel gated_mix__grouped_kv_mqa__glu_gated_glu__prompt_kernel
  .amdhsa_next_free_vgpr 256
  .amdhsa_next_free_sgpr 102
  .amdhsa_accum_offset 256
  .amdhsa_group_segment_fixed_size 0
  .amdhsa_kernarg_size 104
  .amdhsa_user_sgpr_count 2
  .amdhsa_user_sgpr_kernarg_segment_ptr 1
  .amdhsa_system_sgpr_workgroup_id_x 1
.end_amdhsa_kernel
```
